```python
import torch

def _softmax(x, axis=-1):
    return torch.softmax(x, dim=axis)
def _gelu(x):
    return torch.nn.functional.gelu(x, approximate="tanh")
def _silu(x):
    return torch.nn.functional.silu(x)
def _sigmoid(x):
    return torch.sigmoid(x)
def _layernorm(x, axis=-1, eps=1e-5):
    m = x.mean(dim=axis, keepdim=True)
    v = x.var(dim=axis, keepdim=True, unbiased=False)
    return (x - m) / torch.sqrt(v + eps)
def _scatter_add(tgt, idx, src, axis=0):
    return tgt.clone().index_add_(axis, idx, src)
def _segment_sum(src, seg, n):
    out = torch.zeros((n,) + src.shape[1:], dtype=src.dtype)
    return out.index_add_(0, seg, src)
def _pad(x, pw):
    flat = tuple(v for pair in reversed(pw) for v in pair)
    return torch.nn.functional.pad(x, flat)

kernel_name = 'interleave_layers__sliding_local_dilated__ssm_conv_h3__prompt'

def setup_inputs():

    _w = (lambda a: (lambda t: t.to(torch.bfloat16) if t.is_floating_point() else t)(torch.as_tensor(a)))
    def _A_setup():
        B, S, D = 1, 2048, 512
        return {
            "x": _w((lambda *s: torch.randn(*s, dtype=torch.bfloat16) * 0.05)(B, S, D)),
            "wqkv": _w((lambda *s: torch.randn(*s, dtype=torch.bfloat16) * 0.05)(D, 3 * D)),
            "wo": _w((lambda *s: torch.randn(*s, dtype=torch.bfloat16) * 0.05)(D, D)),
        }
    _A_in = _A_setup()

    def _B_setup():
        B, S, D = 1, 2048, 512
        ks = 4
        return {
            "q": _w((lambda *s: torch.randn(*s, dtype=torch.bfloat16) * 0.05)(B, S, D)),
            "k": _w((lambda *s: torch.randn(*s, dtype=torch.bfloat16) * 0.4)(B, S, D)),
            "v": _w((lambda *s: torch.randn(*s, dtype=torch.bfloat16) * 0.4)(B, S, D)),
            "shift_k": _w((lambda *s: torch.randn(*s, dtype=torch.bfloat16) * 0.4)(D, ks) * 0.5),
            "ssm_k": _w((lambda *s: torch.randn(*s, dtype=torch.bfloat16) * 0.8)(D, S) * (1.0 / S ** 0.5)),
            "ssm_D": _w((lambda *s: torch.randn(*s, dtype=torch.bfloat16) * 0.4)(D)),
        }
    _B_in = _B_setup()

    return {
        "A_x": _A_in["x"],
        "A_wqkv": _A_in["wqkv"],
        "A_wo": _A_in["wo"],
        "B_q": _B_in["q"],
        "B_k": _B_in["k"],
        "B_v": _B_in["v"],
        "B_shift_k": _B_in["shift_k"],
        "B_ssm_k": _B_in["ssm_k"],
        "B_ssm_D": _B_in["ssm_D"],
    }

def reference(A_x, A_wqkv, A_wo, B_q, B_k, B_v, B_shift_k, B_ssm_k, B_ssm_D):
    def _A_ref(x, wqkv, wo):
        B, S, D = x.shape
        H = 32; Dh = D // H
        W, dil = 8, 2
        qkv = (lambda x, *d: x.permute(*d))((x @ wqkv).reshape(B, S, 3, H, Dh), 2, 0, 3, 1, 4)
        q, k, v = qkv[0], qkv[1], qkv[2]
        scale = Dh ** -0.5
        pos = torch.arange(S)
        off = torch.arange(W) * dil
        idx = pos[:, None] - off[None, :]
        mask = idx >= 0
        idx_c = torch.where(mask, idx, 0).reshape(-1)
        kg = k[:, :, idx_c, :].reshape(B, H, S, W, Dh)
        vg = v[:, :, idx_c, :].reshape(B, H, S, W, Dh)
        logits = torch.einsum("bhsd,bhswd->bhsw", q, kg) * scale
        logits = torch.where(mask[None, None, :, :], logits, -1e9)
        attn = _softmax(logits, axis=-1)
        o = torch.einsum("bhsw,bhswd->bhsd", attn, vg)
        return (lambda x, *d: x.permute(*d))(o, 0, 2, 1, 3).reshape(B, S, D) @ wo

    def _B_ref(q, k, v, shift_k, ssm_k, ssm_D):
        B, S, D = q.shape
        ks = shift_k.shape[-1]
        k_pad = _pad(k, ((0, 0), (ks - 1, 0), (0, 0)))
        k_shift = torch.zeros_like(k)
        for t in range(ks):
            k_shift = k_shift + k_pad[:, t:t + S, :] * shift_k[:, ks - 1 - t][None, None, :]
        kv = k_shift * v
        L = 2 * S
        kv_pad = _pad(kv, ((0, 0), (0, S), (0, 0)))
        kf_pad = _pad(ssm_k, ((0, 0), (0, S)))
        kv_f = (lambda x, axes=(-2,-1): torch.fft.rfft2(x.float(), dim=axes))(kv_pad[:, None, :, :], axes=(1, 2))
        kf_f = (lambda x, axes=(-2,-1): torch.fft.rfft2(x.float(), dim=axes))(kf_pad[:, None, :], axes=(1, 2))
        kf_f = (lambda x, *d: x.permute(*d))(kf_f, 1, 2, 0)
        y_f = kv_f * kf_f[None, :, :, :]
        y = (lambda x, s, axes=(-2,-1): torch.fft.irfft2(x, s=s, dim=axes).to(torch.bfloat16))(y_f, (1, L), axes=(1, 2))[:, 0, :S, :]
        y = y + kv * ssm_D[None, None, :]
        return q * y

    x = A_x
    x = x + _A_ref(_layernorm(x, axis=-1), A_wqkv, A_wo)
    x = x + _B_ref(_layernorm(x, axis=-1), B_k, B_v, B_shift_k, B_ssm_k, B_ssm_D)
    x = x + _A_ref(_layernorm(x, axis=-1), A_wqkv, A_wo)
    x = x + _B_ref(_layernorm(x, axis=-1), B_k, B_v, B_shift_k, B_ssm_k, B_ssm_D)
    return x
```

```asm
; @launch grid=(256,1,1) block=(256,1,1) lds=163840
.amdgcn_target "amdgcn-amd-amdhsa--gfx950"
.text
.globl interleave_layers__sliding_local_dilated__ssm_conv_h3__prompt_kernel
.p2align 8
.type interleave_layers__sliding_local_dilated__ssm_conv_h3__prompt_kernel,@function
interleave_layers__sliding_local_dilated__ssm_conv_h3__prompt_kernel:
    s_cmp_ge_u32 s2, 256
    s_cbranch_scc1 L_end
    s_load_dwordx16 s[76:91], s[0:1], 0
    s_load_dwordx8 s[92:99], s[0:1], 64
    v_and_b32 v1, 63, v0
    v_lshrrev_b32 v13, 6, v0
    v_and_b32 v2, 15, v0
    v_readfirstlane_b32 s3, v13
    v_bfe_u32 v3, v0, 4, 2
    v_lshlrev_b32 v4, 4, v1
    v_lshrrev_b32 v13, 2, v2
    v_and_b32 v13, 2, v13
    v_xor_b32 v13, v13, v3
    v_lshlrev_b32 v239, 6, v2
    v_lshl_add_u32 v239, v13, 4, v239
    v_add_u32 v5, 40960, v239
    v_lshlrev_b32 v142, 7, v1
    v_and_b32 v142, 0xfff, v142
    s_and_b32 s61, s2, 7
    s_lshr_b32 s62, s2, 3
    s_lshr_b32 s63, s62, 3
    s_lshl_b32 s4, s61, 2
    s_add_u32 s4, s4, s63
    s_and_b32 s5, s62, 7
    s_lshl_b32 s6, s63, 2
    s_lshl_b32 s63, s5, 1
    s_add_u32 s6, s6, s63
    s_and_b32 s63, s61, 2
    s_add_u32 s6, s6, s63
    s_and_b32 s6, s6, 15
    s_lshl_b32 s60, s4, 3
    s_add_u32 s60, s60, s5
    s_add_u32 s7, s5, 4
    s_and_b32 s7, s7, 7
    s_lshl_b32 s65, s3, 10
    s_lshl_b32 s66, s3, 14
    s_mul_i32 s67, s3, 5120
    s_lshl_b32 s68, s60, 15
    s_add_u32 s68, s68, 16777216
    s_lshl_b32 s69, s4, 16
    s_lshl_b32 s62, s5, 7
    s_add_u32 s69, s69, s62
    v_add_u32 v6, s65, v239
    v_add_u32 v6, 1024, v6
    v_add_u32 v7, 40960, v6
    v_add_u32 v8, s67, v239
    v_lshrrev_b32 v14, 5, v1
    v_lshlrev_b32 v9, 10, v14
    v_bfe_u32 v13, v1, 2, 3
    v_lshl_add_u32 v9, v13, 7, v9
    v_lshrrev_b32 v13, 1, v13
    v_xor_b32 v13, s3, v13
    v_lshl_add_u32 v9, v13, 5, v9
    v_and_b32 v13, 3, v1
    v_lshl_add_u32 v9, v13, 3, v9
    v_lshl_add_u32 v236, v14, 11, v9
    v_add_u32 v237, 118784, v236
    v_add_u32 v236, 81920, v236
    v_lshrrev_b32 v13, 2, v1
    v_lshlrev_b32 v10, 10, v13
    v_lshrrev_b32 v14, 4, v1
    v_and_b32 v14, 2, v14
    v_and_b32 v13, 3, v1
    v_xor_b32 v13, v13, v14
    v_lshl_add_u32 v10, v13, 4, v10
    s_lshl_b32 s61, s4, 16
    v_add_u32 v10, s61, v10
    v_add_u32 v11, 4294950912, v10
    v_add_u32 v140, s66, v10
    v_bfe_u32 v13, v1, 3, 2
    v_lshrrev_b32 v14, 5, v1
    v_lshl_add_u32 v13, v14, 3, v13
    s_and_b32 s61, s3, 1
    s_lshl_b32 s61, s61, 4
    s_lshr_b32 s62, s3, 1
    s_lshl_b32 s62, s62, 2
    s_add_u32 s61, s61, s62
    v_add_u32 v13, s61, v13
    v_lshrrev_b32 v14, 4, v1
    v_lshlrev_b32 v14, 1, v14
    v_and_b32 v15, 7, v1
    v_xor_b32 v14, v14, v15
    v_lshlrev_b32 v14, 4, v14
    s_lshl_b32 s61, s5, 7
    v_add_u32 v14, s61, v14
    v_lshl_add_u32 v238, v13, 10, v14
    v_mul_u32_u24 v12, 3072, v13
    v_add_u32 v12, v12, v14
    v_lshrrev_b32 v13, 1, v2
    v_xor_b32 v13, v13, v3
    v_lshlrev_b32 v141, 7, v2
    v_lshl_add_u32 v141, v13, 4, v141
    v_lshrrev_b32 v13, 3, v1
    v_lshrrev_b32 v14, 4, v1
    v_and_b32 v15, 7, v1
    v_xor_b32 v14, v14, v15
    v_lshlrev_b32 v143, 10, v13
    v_lshl_add_u32 v143, v14, 4, v143
    s_lshl_b32 s61, s4, 16
    v_add_u32 v143, s61, v143
    v_and_b32 v13, 1, v1
    v_cmp_eq_u32 s[54:55], 1, v13
    v_lshl_add_u32 v14, v3, 2, v13
    v_cmp_le_u32 s[56:57], v14, v2
    v_add_u32 v14, 2, v14
    v_cmp_le_u32 s[58:59], v14, v2
    v_mov_b32 v136, 0x3f803f80
    v_mov_b32 v137, 0x3f803f80
    v_mov_b32 v138, 0x3f803f80
    v_mov_b32 v139, 0x3f803f80
    s_waitcnt lgkmcnt(0)
    s_mov_b32 s8, s76
    s_and_b32 s9, s77, 0xffff
    s_mov_b32 s10, 2097152
    s_mov_b32 s11, 0x00020000
    s_mov_b32 s12, s78
    s_and_b32 s13, s79, 0xffff
    s_mov_b32 s14, 1572864
    s_mov_b32 s15, 0x00020000
    s_mov_b32 s16, s80
    s_and_b32 s17, s81, 0xffff
    s_mov_b32 s18, 524288
    s_mov_b32 s19, 0x00020000
    s_mov_b32 s20, s84
    s_and_b32 s21, s85, 0xffff
    s_mov_b32 s22, 2097152
    s_mov_b32 s23, 0x00020000
    s_mov_b32 s24, s86
    s_and_b32 s25, s87, 0xffff
    s_mov_b32 s26, 2097152
    s_mov_b32 s27, 0x00020000
    s_mov_b32 s48, s88
    s_and_b32 s49, s89, 0xffff
    s_mov_b32 s50, 4096
    s_mov_b32 s51, 0x00020000
    s_mov_b32 s28, s90
    s_and_b32 s29, s91, 0xffff
    s_mov_b32 s30, 2097152
    s_mov_b32 s31, 0x00020000
    s_mov_b32 s32, s94
    s_and_b32 s33, s95, 0xffff
    s_mov_b32 s34, 2097152
    s_mov_b32 s35, 0x00020000
    s_mov_b32 s36, s96
    s_and_b32 s37, s97, 0xffff
    s_mov_b32 s38, 256
    s_mov_b32 s39, 0x00020000
    s_mov_b32 s40, s98
    s_and_b32 s41, s99, 0xffff
    s_mov_b32 s42, 268435456
    s_mov_b32 s43, 0x00020000
    s_add_u32 s44, s98, 4194304
    s_addc_u32 s45, s99, 0
    s_and_b32 s45, s45, 0xffff
    s_mov_b32 s46, 2097152
    s_mov_b32 s47, 0x00020000
    s_lshl_b32 s61, s60, 2
    s_load_dword s52, s[92:93], s61
    s_mul_i32 s64, s3, 3072
    s_lshl_b32 s75, s3, 6
    s_mov_b32 s81, s64
    s_mov_b32 s82, s75
    s_mov_b32 s84, 0x00010001
    s_mov_b32 s85, 0x00010001
    s_getreg_b32 s77, hwreg(HW_REG_XCC_ID)
    s_and_b32 s77, s77, 0xff
    s_mov_b32 s74, 0
    s_mov_b32 s76, 0
    s_lshl_b32 s80, s6, 6
    s_mov_b32 s83, s80
    s_add_u32 m0, s65, 1024
    s_nop 0
    buffer_load_dwordx4 v140, s[8:11], s83 offen lds
    s_add_u32 s70, s83, s82
    s_and_b32 s70, s70, 1023
    s_add_u32 m0, s67, 0
    s_nop 0
    buffer_load_dwordx4 v11, s[8:11], s70 offen lds
    s_add_u32 s83, s83, 64
    s_and_b32 s83, s83, 1023
    s_mul_i32 s71, s80, 1536
    s_add_u32 m0, s81, 81920
    s_nop 0
    buffer_load_dwordx4 v12, s[12:15], s71 offen offset:0 lds
    buffer_load_dwordx4 v12, s[12:15], s71 offen offset:1024 lds
    buffer_load_dwordx4 v12, s[12:15], s71 offen offset:2048 lds
    s_add_u32 s80, s80, 64
    s_and_b32 s80, s80, 1023
    s_add_u32 m0, s65, 6144
    s_nop 0
    buffer_load_dwordx4 v140, s[8:11], s83 offen lds
    s_add_u32 s83, s83, 64
    s_and_b32 s83, s83, 1023
    s_mul_i32 s71, s80, 1536
    s_add_u32 m0, s81, 94208
    s_nop 0
    buffer_load_dwordx4 v12, s[12:15], s71 offen offset:0 lds
    buffer_load_dwordx4 v12, s[12:15], s71 offen offset:1024 lds
    buffer_load_dwordx4 v12, s[12:15], s71 offen offset:2048 lds
    s_add_u32 s80, s80, 64
    s_and_b32 s80, s80, 1023
    s_add_u32 m0, s65, 11264
    s_nop 0
    buffer_load_dwordx4 v140, s[8:11], s83 offen lds
    s_add_u32 s83, s83, 64
    s_and_b32 s83, s83, 1023
    s_mul_i32 s71, s80, 1536
    s_add_u32 m0, s81, 106496
    s_nop 0
    buffer_load_dwordx4 v12, s[12:15], s71 offen offset:0 lds
    buffer_load_dwordx4 v12, s[12:15], s71 offen offset:1024 lds
    buffer_load_dwordx4 v12, s[12:15], s71 offen offset:2048 lds
    s_add_u32 s80, s80, 64
    s_and_b32 s80, s80, 1023
    s_add_u32 m0, s65, 16384
    s_nop 0
    buffer_load_dwordx4 v140, s[8:11], s83 offen lds
    s_add_u32 s83, s83, 64
    s_and_b32 s83, s83, 1023
    s_mul_i32 s71, s80, 1536
    s_add_u32 m0, s81, 118784
    s_nop 0
    buffer_load_dwordx4 v12, s[12:15], s71 offen offset:0 lds
    buffer_load_dwordx4 v12, s[12:15], s71 offen offset:1024 lds
    buffer_load_dwordx4 v12, s[12:15], s71 offen offset:2048 lds
    s_add_u32 s80, s80, 64
    s_and_b32 s80, s80, 1023
    s_getpc_b64 s[72:73]
L_pc:
    s_lshr_b32 s61, s2, 3
    s_lshl_b32 s61, s61, 2
    s_add_u32 s61, s61, s3
    s_lshl_b32 s61, s61, 8
    v_and_b32 v13, 1, v1
    v_lshl_add_u32 v13, v13, 7, s61
    v_min_u32 v13, L_end-L_pc, v13
    global_load_dword v216, v13, s[72:73]
    s_or_b32 s63, s60, s3
    s_cmp_lg_u32 s63, 0
    s_cbranch_scc1 L_nonce_done
    s_memrealtime s[78:79]
    s_waitcnt lgkmcnt(0)
    s_or_b32 s79, s79, 0x80000000
    s_andn2_b32 s78, s78, 1
    v_mov_b32 v222, s78
    v_mov_b32 v223, s79
    v_mov_b32 v13, 0
    s_mov_b64 exec, 1
    buffer_store_dwordx2 v[222:223], v13, s[36:39], 0 offen sc1
    s_mov_b64 exec, -1
    s_nop 1
L_nonce_done:
    v_and_b32 v13, 7, v0
    v_lshrrev_b32 v14, 3, v0
    v_lshlrev_b32 v15, 11, v14
    v_lshl_add_u32 v15, v13, 4, v15
    s_lshl_b32 s61, s4, 16
    s_lshl_b32 s62, s7, 7
    s_add_u32 s61, s61, s62
    v_add_u32 v15, s61, v15
    v_add_u32 v188, -3072, v15
    v_add_u32 v189, -2048, v15
    v_add_u32 v190, -1024, v15
    v_add_u32 v191, 0, v15
    v_add_u32 v192, 1024, v15
    s_lshl_b32 s62, s7, 9
    v_lshlrev_b32 v193, 6, v13
    buffer_load_dwordx4 v[144:147], v188, s[20:23], 0 offen
    buffer_load_dwordx4 v[148:151], v189, s[20:23], 0 offen
    buffer_load_dwordx4 v[152:155], v190, s[20:23], 0 offen
    buffer_load_dwordx4 v[156:159], v191, s[20:23], 0 offen
    buffer_load_dwordx4 v[160:163], v192, s[20:23], 0 offen
    buffer_load_dwordx4 v[164:167], v191, s[24:27], 0 offen
    buffer_load_dwordx4 v[168:171], v192, s[24:27], 0 offen
    buffer_load_dwordx4 v[172:175], v193, s[48:51], s62 offen offset:0
    buffer_load_dwordx4 v[176:179], v193, s[48:51], s62 offen offset:16
    buffer_load_dwordx4 v[180:183], v193, s[48:51], s62 offen offset:32
    buffer_load_dwordx4 v[184:187], v193, s[48:51], s62 offen offset:48
    s_waitcnt vmcnt(24)
    s_barrier
    s_add_u32 m0, s65, 21504
    s_nop 0
    buffer_load_dwordx4 v140, s[8:11], s83 offen lds
    s_add_u32 s70, s83, s82
    s_and_b32 s70, s70, 1023
    s_add_u32 m0, s67, 20480
    s_nop 0
    buffer_load_dwordx4 v11, s[8:11], s70 offen lds
    s_add_u32 s83, s83, 64
    s_and_b32 s83, s83, 1023
    s_mul_i32 s71, s80, 1536
    s_add_u32 m0, s81, 131072
    s_nop 0
    buffer_load_dwordx4 v12, s[12:15], s71 offen offset:0 lds
    buffer_load_dwordx4 v12, s[12:15], s71 offen offset:1024 lds
    buffer_load_dwordx4 v12, s[12:15], s71 offen offset:2048 lds
    s_add_u32 s80, s80, 64
    s_and_b32 s80, s80, 1023
    ds_read_b128 v[84:87], v239 offset:0
    ds_read_b128 v[88:91], v239 offset:1024
    ds_read_b128 v[92:95], v239 offset:2048
    ds_read_b128 v[96:99], v239 offset:3072
    ds_read_b128 v[100:103], v239 offset:4096
    ds_read_b128 v[124:127], v6 offset:0
    ds_read_b64_tr_b16 a[0:1], v236 offset:0
    ds_read_b64_tr_b16 a[2:3], v236 offset:6144
    ds_read_b64_tr_b16 a[4:5], v236 offset:1024
    ds_read_b64_tr_b16 a[6:7], v236 offset:7168
    ds_read_b64_tr_b16 a[8:9], v236 offset:2048
    ds_read_b64_tr_b16 a[10:11], v236 offset:8192
    s_waitcnt lgkmcnt(0)
    s_waitcnt vmcnt(25)
    s_barrier
    v_cndmask_b32 v84, v84, v136, s[84:85]
    v_cndmask_b32 v85, v85, v136, s[84:85]
    v_cndmask_b32 v86, v86, v136, s[84:85]
    v_cndmask_b32 v87, v87, v136, s[84:85]
    v_mfma_f32_16x16x32_bf16 v[36:39], a[4:7], v[88:91], 0
    ds_read_b128 v[104:107], v239 offset:5120
    v_mfma_f32_16x16x32_bf16 v[56:59], v[88:91], a[8:11], 0
    s_add_u32 m0, s65, 26624
    ds_read_b128 v[108:111], v239 offset:6144
    v_mfma_f32_16x16x32_bf16 v[16:19], a[0:3], v[88:91], 0
    buffer_load_dwordx4 v140, s[8:11], s83 offen lds
    ds_read_b128 v[112:115], v239 offset:7168
    v_mfma_f32_16x16x32_bf16 v[40:43], a[4:7], v[92:95], 0
    ds_read_b128 v[116:119], v239 offset:8192
    v_mfma_f32_16x16x32_bf16 v[60:63], v[92:95], a[8:11], 0
    s_add_u32 s83, s83, 64
    ds_read_b128 v[120:123], v239 offset:9216
    v_mfma_f32_16x16x32_bf16 v[20:23], a[0:3], v[92:95], 0
    s_and_b32 s83, s83, 1023
    ds_read_b128 v[128:131], v6 offset:5120
    v_mfma_f32_16x16x32_bf16 v[44:47], a[4:7], v[96:99], 0
    ds_read_b64_tr_b16 a[12:13], v236 offset:12288
    v_mfma_f32_16x16x32_bf16 v[64:67], v[96:99], a[8:11], 0
    s_mul_i32 s71, s80, 1536
    ds_read_b64_tr_b16 a[14:15], v236 offset:18432
    v_mfma_f32_16x16x32_bf16 v[24:27], a[0:3], v[96:99], 0
    s_add_u32 m0, s81, 143360
    ds_read_b64_tr_b16 a[16:17], v236 offset:13312
    v_mfma_f32_16x16x32_bf16 v[48:51], a[4:7], v[100:103], 0
    buffer_load_dwordx4 v12, s[12:15], s71 offen offset:0 lds
    ds_read_b64_tr_b16 a[18:19], v236 offset:19456
    v_mfma_f32_16x16x32_bf16 v[68:71], v[100:103], a[8:11], 0
    ds_read_b64_tr_b16 a[20:21], v236 offset:14336
    v_mfma_f32_16x16x32_bf16 v[28:31], a[0:3], v[100:103], 0
    buffer_load_dwordx4 v12, s[12:15], s71 offen offset:1024 lds
    ds_read_b64_tr_b16 a[22:23], v236 offset:20480
    v_mfma_f32_16x16x32_bf16 v[224:227], a[0:3], v[136:139], 0
    buffer_load_dwordx4 v12, s[12:15], s71 offen offset:2048 lds
    v_mfma_f32_16x16x32_bf16 v[32:35], a[4:7], v[84:87], 0
    v_mfma_f32_16x16x32_bf16 v[52:55], v[84:87], a[8:11], 0
    s_add_u32 s80, s80, 64
    v_mfma_f32_16x16x32_bf16 v[196:199], v[136:139], v[124:127], 0
    s_and_b32 s80, s80, 1023
    v_mfma_f32_16x16x32_bf16 v[200:203], v[124:127], v[124:127], 0
    s_waitcnt lgkmcnt(0)
    s_waitcnt vmcnt(25)
    s_barrier
    v_cndmask_b32 v104, v104, v136, s[84:85]
    v_cndmask_b32 v105, v105, v136, s[84:85]
    v_cndmask_b32 v106, v106, v136, s[84:85]
    v_cndmask_b32 v107, v107, v136, s[84:85]
    v_mfma_f32_16x16x32_bf16 v[36:39], a[16:19], v[108:111], v[36:39]
    ds_read_b128 v[84:87], v239 offset:10240
    v_mfma_f32_16x16x32_bf16 v[56:59], v[108:111], a[20:23], v[56:59]
    s_add_u32 m0, s65, 31744
    ds_read_b128 v[88:91], v239 offset:11264
    v_mfma_f32_16x16x32_bf16 v[16:19], a[12:15], v[108:111], v[16:19]
    buffer_load_dwordx4 v140, s[8:11], s83 offen lds
    ds_read_b128 v[92:95], v239 offset:12288
    v_mfma_f32_16x16x32_bf16 v[40:43], a[16:19], v[112:115], v[40:43]
    ds_read_b128 v[96:99], v239 offset:13312
    v_mfma_f32_16x16x32_bf16 v[60:63], v[112:115], a[20:23], v[60:63]
    s_add_u32 s83, s83, 64
    ds_read_b128 v[100:103], v239 offset:14336
    v_mfma_f32_16x16x32_bf16 v[20:23], a[12:15], v[112:115], v[20:23]
    s_and_b32 s83, s83, 1023
    ds_read_b128 v[124:127], v6 offset:10240
    v_mfma_f32_16x16x32_bf16 v[44:47], a[16:19], v[116:119], v[44:47]
    ds_read_b64_tr_b16 a[24:25], v236 offset:24576
    v_mfma_f32_16x16x32_bf16 v[64:67], v[116:119], a[20:23], v[64:67]
    s_mul_i32 s71, s80, 1536
    ds_read_b64_tr_b16 a[26:27], v236 offset:30720
    v_mfma_f32_16x16x32_bf16 v[24:27], a[12:15], v[116:119], v[24:27]
    s_add_u32 m0, s81, 81920
    ds_read_b64_tr_b16 a[28:29], v236 offset:25600
    v_mfma_f32_16x16x32_bf16 v[48:51], a[16:19], v[120:123], v[48:51]
    buffer_load_dwordx4 v12, s[12:15], s71 offen offset:0 lds
    ds_read_b64_tr_b16 a[30:31], v236 offset:31744
    v_mfma_f32_16x16x32_bf16 v[68:71], v[120:123], a[20:23], v[68:71]
    ds_read_b64_tr_b16 a[32:33], v236 offset:26624
    v_mfma_f32_16x16x32_bf16 v[28:31], a[12:15], v[120:123], v[28:31]
    buffer_load_dwordx4 v12, s[12:15], s71 offen offset:1024 lds
    ds_read_b64_tr_b16 a[34:35], v236 offset:32768
    v_mfma_f32_16x16x32_bf16 v[224:227], a[12:15], v[136:139], v[224:227]
    buffer_load_dwordx4 v12, s[12:15], s71 offen offset:2048 lds
    v_mfma_f32_16x16x32_bf16 v[32:35], a[16:19], v[104:107], v[32:35]
    v_mfma_f32_16x16x32_bf16 v[52:55], v[104:107], a[20:23], v[52:55]
    s_add_u32 s80, s80, 64
    v_mfma_f32_16x16x32_bf16 v[196:199], v[136:139], v[128:131], v[196:199]
    s_and_b32 s80, s80, 1023
    v_mfma_f32_16x16x32_bf16 v[200:203], v[128:131], v[128:131], v[200:203]
    s_waitcnt lgkmcnt(0)
    s_waitcnt vmcnt(25)
    s_barrier
    v_mov_b32 v13, 0
    buffer_load_dwordx2 v[220:221], v13, s[36:39], 0 offen sc1
    v_cndmask_b32 v84, v84, v136, s[84:85]
    v_cndmask_b32 v85, v85, v136, s[84:85]
    v_cndmask_b32 v86, v86, v136, s[84:85]
    v_cndmask_b32 v87, v87, v136, s[84:85]
    v_mfma_f32_16x16x32_bf16 v[36:39], a[28:31], v[88:91], v[36:39]
    ds_read_b128 v[104:107], v239 offset:15360
    v_mfma_f32_16x16x32_bf16 v[56:59], v[88:91], a[32:35], v[56:59]
    s_add_u32 m0, s65, 36864
    ds_read_b128 v[108:111], v239 offset:16384
    v_mfma_f32_16x16x32_bf16 v[16:19], a[24:27], v[88:91], v[16:19]
    buffer_load_dwordx4 v140, s[8:11], s83 offen lds
    ds_read_b128 v[112:115], v239 offset:17408
    v_mfma_f32_16x16x32_bf16 v[40:43], a[28:31], v[92:95], v[40:43]
    ds_read_b128 v[116:119], v239 offset:18432
    v_mfma_f32_16x16x32_bf16 v[60:63], v[92:95], a[32:35], v[60:63]
    s_add_u32 s83, s83, 64
    ds_read_b128 v[120:123], v239 offset:19456
    v_mfma_f32_16x16x32_bf16 v[20:23], a[24:27], v[92:95], v[20:23]
    s_and_b32 s83, s83, 1023
    ds_read_b128 v[128:131], v6 offset:15360
    v_mfma_f32_16x16x32_bf16 v[44:47], a[28:31], v[96:99], v[44:47]
    ds_read_b128 v[132:135], v8 offset:0
    v_mfma_f32_16x16x32_bf16 v[64:67], v[96:99], a[32:35], v[64:67]
    s_mul_i32 s71, s80, 1536
    ds_read_b64_tr_b16 a[36:37], v237 offset:0
    v_mfma_f32_16x16x32_bf16 v[24:27], a[24:27], v[96:99], v[24:27]
    s_add_u32 m0, s81, 94208
    ds_read_b64_tr_b16 a[38:39], v237 offset:6144
    v_mfma_f32_16x16x32_bf16 v[48:51], a[28:31], v[100:103], v[48:51]
    buffer_load_dwordx4 v12, s[12:15], s71 offen offset:0 lds
    ds_read_b64_tr_b16 a[40:41], v237 offset:1024
    v_mfma_f32_16x16x32_bf16 v[68:71], v[100:103], a[32:35], v[68:71]
    ds_read_b64_tr_b16 a[42:43], v237 offset:7168
    v_mfma_f32_16x16x32_bf16 v[28:31], a[24:27], v[100:103], v[28:31]
    buffer_load_dwordx4 v12, s[12:15], s71 offen offset:1024 lds
    ds_read_b64_tr_b16 a[44:45], v237 offset:2048
    v_mfma_f32_16x16x32_bf16 v[224:227], a[24:27], v[136:139], v[224:227]
    buffer_load_dwordx4 v12, s[12:15], s71 offen offset:2048 lds
    ds_read_b64_tr_b16 a[46:47], v237 offset:8192
    v_mfma_f32_16x16x32_bf16 v[32:35], a[28:31], v[84:87], v[32:35]
    v_mfma_f32_16x16x32_bf16 v[52:55], v[84:87], a[32:35], v[52:55]
    s_add_u32 s80, s80, 64
    v_mfma_f32_16x16x32_bf16 v[196:199], v[136:139], v[124:127], v[196:199]
    s_and_b32 s80, s80, 1023
    v_mfma_f32_16x16x32_bf16 v[200:203], v[124:127], v[124:127], v[200:203]
    s_waitcnt lgkmcnt(0)
    s_waitcnt vmcnt(13)
    s_barrier
    v_cndmask_b32 v104, v104, v136, s[84:85]
    v_cndmask_b32 v105, v105, v136, s[84:85]
    v_cndmask_b32 v106, v106, v136, s[84:85]
    v_cndmask_b32 v107, v107, v136, s[84:85]
    v_mfma_f32_16x16x32_bf16 v[36:39], a[40:43], v[108:111], v[36:39]
    ds_read_b128 v[84:87], v239 offset:20480
    v_mfma_f32_16x16x32_bf16 v[56:59], v[108:111], a[44:47], v[56:59]
    s_add_u32 m0, s65, 41984
    ds_read_b128 v[88:91], v239 offset:21504
    v_mfma_f32_16x16x32_bf16 v[16:19], a[36:39], v[108:111], v[16:19]
    buffer_load_dwordx4 v140, s[8:11], s83 offen lds
    ds_read_b128 v[92:95], v239 offset:22528
    v_mfma_f32_16x16x32_bf16 v[40:43], a[40:43], v[112:115], v[40:43]
    s_add_u32 s70, s83, s82
    ds_read_b128 v[96:99], v239 offset:23552
    v_mfma_f32_16x16x32_bf16 v[60:63], v[112:115], a[44:47], v[60:63]
    s_and_b32 s70, s70, 1023
    ds_read_b128 v[100:103], v239 offset:24576
    v_mfma_f32_16x16x32_bf16 v[20:23], a[36:39], v[112:115], v[20:23]
    s_add_u32 m0, s67, 40960
    ds_read_b128 v[124:127], v6 offset:20480
    v_mfma_f32_16x16x32_bf16 v[44:47], a[40:43], v[116:119], v[44:47]
    ds_read_b64_tr_b16 a[48:49], v237 offset:12288
    v_mfma_f32_16x16x32_bf16 v[64:67], v[116:119], a[44:47], v[64:67]
    buffer_load_dwordx4 v11, s[8:11], s70 offen lds
    ds_read_b64_tr_b16 a[50:51], v237 offset:18432
    v_mfma_f32_16x16x32_bf16 v[24:27], a[36:39], v[116:119], v[24:27]
    s_add_u32 s83, s83, 64
    ds_read_b64_tr_b16 a[52:53], v237 offset:13312
    v_mfma_f32_16x16x32_bf16 v[48:51], a[40:43], v[120:123], v[48:51]
    s_and_b32 s83, s83, 1023
    ds_read_b64_tr_b16 a[54:55], v237 offset:19456
    v_mfma_f32_16x16x32_bf16 v[68:71], v[120:123], a[44:47], v[68:71]
    s_mul_i32 s71, s80, 1536
    ds_read_b64_tr_b16 a[56:57], v237 offset:14336
    v_mfma_f32_16x16x32_bf16 v[28:31], a[36:39], v[120:123], v[28:31]
    s_add_u32 m0, s81, 106496
    ds_read_b64_tr_b16 a[58:59], v237 offset:20480
    v_mfma_f32_16x16x32_bf16 v[224:227], a[36:39], v[136:139], v[224:227]
    v_mfma_f32_16x16x32_bf16 v[32:35], a[40:43], v[104:107], v[32:35]
    buffer_load_dwordx4 v12, s[12:15], s71 offen offset:0 lds
    v_mfma_f32_16x16x32_bf16 v[52:55], v[104:107], a[44:47], v[52:55]
    buffer_load_dwordx4 v12, s[12:15], s71 offen offset:1024 lds
    v_mfma_f32_16x16x32_bf16 v[196:199], v[136:139], v[128:131], v[196:199]
    buffer_load_dwordx4 v12, s[12:15], s71 offen offset:2048 lds
    v_mfma_f32_16x16x32_bf16 v[200:203], v[128:131], v[128:131], v[200:203]
    s_add_u32 s80, s80, 64
    v_mfma_f32_16x16x32_bf16 v[204:207], v[136:139], v[132:135], 0
    s_and_b32 s80, s80, 1023
    v_mfma_f32_16x16x32_bf16 v[208:211], v[132:135], v[132:135], 0
    s_waitcnt lgkmcnt(0)
    s_waitcnt vmcnt(14)
    s_barrier
    v_cndmask_b32 v84, v84, v136, s[84:85]
    v_cndmask_b32 v85, v85, v136, s[84:85]
    v_cndmask_b32 v86, v86, v136, s[84:85]
    v_cndmask_b32 v87, v87, v136, s[84:85]
    v_mfma_f32_16x16x32_bf16 v[36:39], a[52:55], v[88:91], v[36:39]
    ds_read_b128 v[104:107], v239 offset:25600
    v_mfma_f32_16x16x32_bf16 v[56:59], v[88:91], a[56:59], v[56:59]
    s_add_u32 m0, s65, 47104
    ds_read_b128 v[108:111], v239 offset:26624
    v_mfma_f32_16x16x32_bf16 v[16:19], a[48:51], v[88:91], v[16:19]
    buffer_load_dwordx4 v140, s[8:11], s83 offen lds
    ds_read_b128 v[112:115], v239 offset:27648
    v_mfma_f32_16x16x32_bf16 v[40:43], a[52:55], v[92:95], v[40:43]
    ds_read_b128 v[116:119], v239 offset:28672
    v_mfma_f32_16x16x32_bf16 v[60:63], v[92:95], a[56:59], v[60:63]
    s_add_u32 s83, s83, 64
    ds_read_b128 v[120:123], v239 offset:29696
    v_mfma_f32_16x16x32_bf16 v[20:23], a[48:51], v[92:95], v[20:23]
    s_and_b32 s83, s83, 1023
    ds_read_b128 v[128:131], v6 offset:25600
    v_mfma_f32_16x16x32_bf16 v[44:47], a[52:55], v[96:99], v[44:47]
    ds_read_b64_tr_b16 a[60:61], v237 offset:24576
    v_mfma_f32_16x16x32_bf16 v[64:67], v[96:99], a[56:59], v[64:67]
    s_mul_i32 s71, s80, 1536
    ds_read_b64_tr_b16 a[62:63], v237 offset:30720
    v_mfma_f32_16x16x32_bf16 v[24:27], a[48:51], v[96:99], v[24:27]
    s_add_u32 m0, s81, 118784
    ds_read_b64_tr_b16 a[64:65], v237 offset:25600
    v_mfma_f32_16x16x32_bf16 v[48:51], a[52:55], v[100:103], v[48:51]
    buffer_load_dwordx4 v12, s[12:15], s71 offen offset:0 lds
    ds_read_b64_tr_b16 a[66:67], v237 offset:31744
    v_mfma_f32_16x16x32_bf16 v[68:71], v[100:103], a[56:59], v[68:71]
    ds_read_b64_tr_b16 a[68:69], v237 offset:26624
    v_mfma_f32_16x16x32_bf16 v[28:31], a[48:51], v[100:103], v[28:31]
    buffer_load_dwordx4 v12, s[12:15], s71 offen offset:1024 lds
    ds_read_b64_tr_b16 a[70:71], v237 offset:32768
    v_mfma_f32_16x16x32_bf16 v[224:227], a[48:51], v[136:139], v[224:227]
    buffer_load_dwordx4 v12, s[12:15], s71 offen offset:2048 lds
    v_mfma_f32_16x16x32_bf16 v[32:35], a[52:55], v[84:87], v[32:35]
    v_mfma_f32_16x16x32_bf16 v[52:55], v[84:87], a[56:59], v[52:55]
    s_add_u32 s80, s80, 64
    v_mfma_f32_16x16x32_bf16 v[196:199], v[136:139], v[124:127], v[196:199]
    s_and_b32 s80, s80, 1023
    v_mfma_f32_16x16x32_bf16 v[200:203], v[124:127], v[124:127], v[200:203]
    s_waitcnt lgkmcnt(0)
    v_lshlrev_b32 v240, 16, v144
    v_and_b32 v241, 0xffff0000, v144
    v_lshlrev_b32 v242, 16, v148
    v_and_b32 v243, 0xffff0000, v148
    v_lshlrev_b32 v244, 16, v152
    v_and_b32 v245, 0xffff0000, v152
    v_lshlrev_b32 v246, 16, v156
    v_and_b32 v247, 0xffff0000, v156
    v_lshlrev_b32 v248, 16, v160
    v_and_b32 v249, 0xffff0000, v160
    v_lshlrev_b32 v188, 16, v172
    v_and_b32 v190, 0xffff0000, v172
    v_lshlrev_b32 v192, 16, v173
    v_and_b32 v194, 0xffff0000, v173
    v_lshlrev_b32 v189, 16, v174
    v_and_b32 v191, 0xffff0000, v174
    v_lshlrev_b32 v193, 16, v175
    v_and_b32 v195, 0xffff0000, v175
    v_lshlrev_b32 v250, 16, v164
    v_and_b32 v251, 0xffff0000, v164
    v_lshlrev_b32 v252, 16, v168
    v_and_b32 v253, 0xffff0000, v168
    v_pk_mul_f32 v[254:255], v[240:241], v[194:195]
    v_pk_mul_f32 v[212:213], v[242:243], v[194:195]
    v_pk_fma_f32 v[254:255], v[242:243], v[192:193], v[254:255]
    v_pk_fma_f32 v[212:213], v[244:245], v[192:193], v[212:213]
    v_pk_fma_f32 v[254:255], v[244:245], v[190:191], v[254:255]
    v_pk_fma_f32 v[212:213], v[246:247], v[190:191], v[212:213]
    v_pk_fma_f32 v[254:255], v[246:247], v[188:189], v[254:255]
    v_pk_fma_f32 v[212:213], v[248:249], v[188:189], v[212:213]
    v_cvt_pk_bf16_f32 v255, v254, v255
    v_lshlrev_b32 v254, 16, v255
    v_and_b32 v255, 0xffff0000, v255
    v_cvt_pk_bf16_f32 v213, v212, v213
    v_lshlrev_b32 v212, 16, v213
    v_and_b32 v213, 0xffff0000, v213
    v_pk_mul_f32 v[254:255], v[254:255], v[250:251]
    v_pk_mul_f32 v[212:213], v[212:213], v[252:253]
    v_cvt_pk_bf16_f32 v144, v212, v254
    v_cvt_pk_bf16_f32 v148, v213, v255
    v_lshlrev_b32 v240, 16, v145
    v_and_b32 v241, 0xffff0000, v145
    v_lshlrev_b32 v242, 16, v149
    v_and_b32 v243, 0xffff0000, v149
    v_lshlrev_b32 v244, 16, v153
    v_and_b32 v245, 0xffff0000, v153
    v_lshlrev_b32 v246, 16, v157
    v_and_b32 v247, 0xffff0000, v157
    v_lshlrev_b32 v248, 16, v161
    v_and_b32 v249, 0xffff0000, v161
    v_lshlrev_b32 v188, 16, v176
    v_and_b32 v190, 0xffff0000, v176
    v_lshlrev_b32 v192, 16, v177
    v_and_b32 v194, 0xffff0000, v177
    v_lshlrev_b32 v189, 16, v178
    v_and_b32 v191, 0xffff0000, v178
    v_lshlrev_b32 v193, 16, v179
    v_and_b32 v195, 0xffff0000, v179
    v_lshlrev_b32 v250, 16, v165
    v_and_b32 v251, 0xffff0000, v165
    v_lshlrev_b32 v252, 16, v169
    v_and_b32 v253, 0xffff0000, v169
    v_pk_mul_f32 v[254:255], v[240:241], v[194:195]
    v_pk_mul_f32 v[212:213], v[242:243], v[194:195]
    v_pk_fma_f32 v[254:255], v[242:243], v[192:193], v[254:255]
    v_pk_fma_f32 v[212:213], v[244:245], v[192:193], v[212:213]
    v_pk_fma_f32 v[254:255], v[244:245], v[190:191], v[254:255]
    v_pk_fma_f32 v[212:213], v[246:247], v[190:191], v[212:213]
    v_pk_fma_f32 v[254:255], v[246:247], v[188:189], v[254:255]
    v_pk_fma_f32 v[212:213], v[248:249], v[188:189], v[212:213]
    v_cvt_pk_bf16_f32 v255, v254, v255
    v_lshlrev_b32 v254, 16, v255
    v_and_b32 v255, 0xffff0000, v255
    v_cvt_pk_bf16_f32 v213, v212, v213
    v_lshlrev_b32 v212, 16, v213
    v_and_b32 v213, 0xffff0000, v213
    v_pk_mul_f32 v[254:255], v[254:255], v[250:251]
    v_pk_mul_f32 v[212:213], v[212:213], v[252:253]
    v_cvt_pk_bf16_f32 v145, v212, v254
    v_cvt_pk_bf16_f32 v149, v213, v255
    v_lshlrev_b32 v240, 16, v146
    v_and_b32 v241, 0xffff0000, v146
    v_lshlrev_b32 v242, 16, v150
    v_and_b32 v243, 0xffff0000, v150
    v_lshlrev_b32 v244, 16, v154
    v_and_b32 v245, 0xffff0000, v154
    v_lshlrev_b32 v246, 16, v158
    v_and_b32 v247, 0xffff0000, v158
    v_lshlrev_b32 v248, 16, v162
    v_and_b32 v249, 0xffff0000, v162
    v_lshlrev_b32 v188, 16, v180
    v_and_b32 v190, 0xffff0000, v180
    v_lshlrev_b32 v192, 16, v181
    v_and_b32 v194, 0xffff0000, v181
    v_lshlrev_b32 v189, 16, v182
    v_and_b32 v191, 0xffff0000, v182
    v_lshlrev_b32 v193, 16, v183
    v_and_b32 v195, 0xffff0000, v183
    v_lshlrev_b32 v250, 16, v166
    v_and_b32 v251, 0xffff0000, v166
    v_lshlrev_b32 v252, 16, v170
    v_and_b32 v253, 0xffff0000, v170
    v_pk_mul_f32 v[254:255], v[240:241], v[194:195]
    v_pk_mul_f32 v[212:213], v[242:243], v[194:195]
    v_pk_fma_f32 v[254:255], v[242:243], v[192:193], v[254:255]
    v_pk_fma_f32 v[212:213], v[244:245], v[192:193], v[212:213]
    v_pk_fma_f32 v[254:255], v[244:245], v[190:191], v[254:255]
    v_pk_fma_f32 v[212:213], v[246:247], v[190:191], v[212:213]
    v_pk_fma_f32 v[254:255], v[246:247], v[188:189], v[254:255]
    v_pk_fma_f32 v[212:213], v[248:249], v[188:189], v[212:213]
    v_cvt_pk_bf16_f32 v255, v254, v255
    v_lshlrev_b32 v254, 16, v255
    v_and_b32 v255, 0xffff0000, v255
    v_cvt_pk_bf16_f32 v213, v212, v213
    v_lshlrev_b32 v212, 16, v213
    v_and_b32 v213, 0xffff0000, v213
    v_pk_mul_f32 v[254:255], v[254:255], v[250:251]
    v_pk_mul_f32 v[212:213], v[212:213], v[252:253]
    v_cvt_pk_bf16_f32 v146, v212, v254
    v_cvt_pk_bf16_f32 v150, v213, v255
    v_lshlrev_b32 v240, 16, v147
    v_and_b32 v241, 0xffff0000, v147
    v_lshlrev_b32 v242, 16, v151
    v_and_b32 v243, 0xffff0000, v151
    v_lshlrev_b32 v244, 16, v155
    v_and_b32 v245, 0xffff0000, v155
    v_lshlrev_b32 v246, 16, v159
    v_and_b32 v247, 0xffff0000, v159
    v_lshlrev_b32 v248, 16, v163
    v_and_b32 v249, 0xffff0000, v163
    v_lshlrev_b32 v188, 16, v184
    v_and_b32 v190, 0xffff0000, v184
    v_lshlrev_b32 v192, 16, v185
    v_and_b32 v194, 0xffff0000, v185
    v_lshlrev_b32 v189, 16, v186
    v_and_b32 v191, 0xffff0000, v186
    v_lshlrev_b32 v193, 16, v187
    v_and_b32 v195, 0xffff0000, v187
    v_lshlrev_b32 v250, 16, v167
    v_and_b32 v251, 0xffff0000, v167
    v_lshlrev_b32 v252, 16, v171
    v_and_b32 v253, 0xffff0000, v171
    v_pk_mul_f32 v[254:255], v[240:241], v[194:195]
    v_pk_mul_f32 v[212:213], v[242:243], v[194:195]
    v_pk_fma_f32 v[254:255], v[242:243], v[192:193], v[254:255]
    v_pk_fma_f32 v[212:213], v[244:245], v[192:193], v[212:213]
    v_pk_fma_f32 v[254:255], v[244:245], v[190:191], v[254:255]
    v_pk_fma_f32 v[212:213], v[246:247], v[190:191], v[212:213]
    v_pk_fma_f32 v[254:255], v[246:247], v[188:189], v[254:255]
    v_pk_fma_f32 v[212:213], v[248:249], v[188:189], v[212:213]
    v_cvt_pk_bf16_f32 v255, v254, v255
    v_lshlrev_b32 v254, 16, v255
    v_and_b32 v255, 0xffff0000, v255
    v_cvt_pk_bf16_f32 v213, v212, v213
    v_lshlrev_b32 v212, 16, v213
    v_and_b32 v213, 0xffff0000, v213
    v_pk_mul_f32 v[254:255], v[254:255], v[250:251]
    v_pk_mul_f32 v[212:213], v[212:213], v[252:253]
    v_cvt_pk_bf16_f32 v147, v212, v254
    v_cvt_pk_bf16_f32 v151, v213, v255
    v_and_b32 v13, 7, v0
    v_lshrrev_b32 v14, 3, v0
    v_sub_u32 v14, 31, v14
    v_lshlrev_b32 v15, 2, v13
    v_xor_b32 v14, v14, v15
    v_lshlrev_b32 v14, 2, v14
    v_lshl_add_u32 v14, v13, 10, v14
    v_add_u32 v14, 155648, v14
    ds_write_b32 v14, v144 offset:0
    ds_write_b32 v14, v148 offset:128
    ds_write_b32 v14, v145 offset:256
    ds_write_b32 v14, v149 offset:384
    ds_write_b32 v14, v146 offset:512
    ds_write_b32 v14, v150 offset:640
    ds_write_b32 v14, v147 offset:768
    ds_write_b32 v14, v151 offset:896
    v_lshrrev_b32 v13, 3, v0
    v_and_b32 v14, 7, v0
    v_lshrrev_b32 v15, 3, v13
    v_xor_b32 v188, v14, v15
    v_lshlrev_b32 v188, 4, v188
    v_lshl_add_u32 v188, v13, 7, v188
    v_add_u32 v188, 155648, v188
    v_xor_b32 v189, 64, v188
    v_lshlrev_b32 v190, 12, v13
    v_lshl_add_u32 v190, v14, 4, v190
    s_lshl_b32 s61, s7, 18
    s_lshl_b32 s62, s4, 7
    s_sub_u32 s61, s61, s62
    s_add_u32 s61, s61, 3968
    s_add_u32 s62, s61, 131072
    s_waitcnt lgkmcnt(0)
    s_barrier
    ds_read_b128 v[164:167], v188
    ds_read_b128 v[168:171], v189 offset:4096
    s_waitcnt lgkmcnt(0)
    buffer_store_dwordx4 v[164:167], v190, s[40:43], s61 offen sc1
    buffer_store_dwordx4 v[168:171], v190, s[40:43], s62 offen sc1
    s_waitcnt vmcnt(16)
    s_barrier
    v_cndmask_b32 v104, v104, v136, s[84:85]
    v_cndmask_b32 v105, v105, v136, s[84:85]
    v_cndmask_b32 v106, v106, v136, s[84:85]
    v_cndmask_b32 v107, v107, v136, s[84:85]
    v_mfma_f32_16x16x32_bf16 v[36:39], a[64:67], v[108:111], v[36:39]
    ds_read_b128 v[84:87], v239 offset:30720
    v_mfma_f32_16x16x32_bf16 v[56:59], v[108:111], a[68:71], v[56:59]
    s_add_u32 m0, s65, 52224
    ds_read_b128 v[88:91], v239 offset:31744
    v_mfma_f32_16x16x32_bf16 v[16:19], a[60:63], v[108:111], v[16:19]
    buffer_load_dwordx4 v140, s[8:11], s83 offen lds
    ds_read_b128 v[92:95], v239 offset:32768
    v_mfma_f32_16x16x32_bf16 v[40:43], a[64:67], v[112:115], v[40:43]
    ds_read_b128 v[96:99], v239 offset:33792
    v_mfma_f32_16x16x32_bf16 v[60:63], v[112:115], a[68:71], v[60:63]
    s_add_u32 s83, s83, 64
    ds_read_b128 v[100:103], v239 offset:34816
    v_mfma_f32_16x16x32_bf16 v[20:23], a[60:63], v[112:115], v[20:23]
    s_and_b32 s83, s83, 1023
    ds_read_b128 v[124:127], v6 offset:30720
    v_mfma_f32_16x16x32_bf16 v[44:47], a[64:67], v[116:119], v[44:47]
    ds_read_b64_tr_b16 a[72:73], v236 offset:0
    v_mfma_f32_16x16x32_bf16 v[64:67], v[116:119], a[68:71], v[64:67]
    s_mul_i32 s71, s80, 1536
    ds_read_b64_tr_b16 a[74:75], v236 offset:6144
    v_mfma_f32_16x16x32_bf16 v[24:27], a[60:63], v[116:119], v[24:27]
    s_add_u32 m0, s81, 131072
    ds_read_b64_tr_b16 a[76:77], v236 offset:1024
    v_mfma_f32_16x16x32_bf16 v[48:51], a[64:67], v[120:123], v[48:51]
    buffer_load_dwordx4 v12, s[12:15], s71 offen offset:0 lds
    ds_read_b64_tr_b16 a[78:79], v236 offset:7168
    v_mfma_f32_16x16x32_bf16 v[68:71], v[120:123], a[68:71], v[68:71]
    ds_read_b64_tr_b16 a[80:81], v236 offset:2048
    v_mfma_f32_16x16x32_bf16 v[28:31], a[60:63], v[120:123], v[28:31]
    buffer_load_dwordx4 v12, s[12:15], s71 offen offset:1024 lds
    ds_read_b64_tr_b16 a[82:83], v236 offset:8192
    v_mfma_f32_16x16x32_bf16 v[224:227], a[60:63], v[136:139], v[224:227]
    buffer_load_dwordx4 v12, s[12:15], s71 offen offset:2048 lds
    v_mfma_f32_16x16x32_bf16 v[32:35], a[64:67], v[104:107], v[32:35]
    v_mfma_f32_16x16x32_bf16 v[52:55], v[104:107], a[68:71], v[52:55]
    s_add_u32 s80, s80, 64
    v_mfma_f32_16x16x32_bf16 v[196:199], v[136:139], v[128:131], v[196:199]
    s_and_b32 s80, s80, 1023
    v_mfma_f32_16x16x32_bf16 v[200:203], v[128:131], v[128:131], v[200:203]
    s_waitcnt lgkmcnt(0)
    s_waitcnt vmcnt(15)
    s_barrier
    v_cndmask_b32 v84, v84, v136, s[84:85]
    v_cndmask_b32 v85, v85, v136, s[84:85]
    v_cndmask_b32 v86, v86, v136, s[84:85]
    v_cndmask_b32 v87, v87, v136, s[84:85]
    v_mfma_f32_16x16x32_bf16 v[36:39], a[76:79], v[88:91], v[36:39]
    ds_read_b128 v[104:107], v239 offset:35840
    v_mfma_f32_16x16x32_bf16 v[56:59], v[88:91], a[80:83], v[56:59]
    s_add_u32 m0, s65, 57344
    ds_read_b128 v[108:111], v239 offset:36864
    v_mfma_f32_16x16x32_bf16 v[16:19], a[72:75], v[88:91], v[16:19]
    buffer_load_dwordx4 v140, s[8:11], s83 offen lds
    ds_read_b128 v[112:115], v239 offset:37888
    v_mfma_f32_16x16x32_bf16 v[40:43], a[76:79], v[92:95], v[40:43]
    ds_read_b128 v[116:119], v239 offset:38912
    v_mfma_f32_16x16x32_bf16 v[60:63], v[92:95], a[80:83], v[60:63]
    s_add_u32 s83, s83, 64
    ds_read_b128 v[120:123], v239 offset:39936
    v_mfma_f32_16x16x32_bf16 v[20:23], a[72:75], v[92:95], v[20:23]
    s_and_b32 s83, s83, 1023
    ds_read_b128 v[128:131], v6 offset:35840
    v_mfma_f32_16x16x32_bf16 v[44:47], a[76:79], v[96:99], v[44:47]
    ds_read_b128 v[132:135], v8 offset:20480
    v_mfma_f32_16x16x32_bf16 v[64:67], v[96:99], a[80:83], v[64:67]
    s_mul_i32 s71, s80, 1536
    ds_read_b64_tr_b16 a[84:85], v236 offset:12288
    v_mfma_f32_16x16x32_bf16 v[24:27], a[72:75], v[96:99], v[24:27]
    s_add_u32 m0, s81, 143360
    ds_read_b64_tr_b16 a[86:87], v236 offset:18432
    v_mfma_f32_16x16x32_bf16 v[48:51], a[76:79], v[100:103], v[48:51]
    buffer_load_dwordx4 v12, s[12:15], s71 offen offset:0 lds
    ds_read_b64_tr_b16 a[88:89], v236 offset:13312
    v_mfma_f32_16x16x32_bf16 v[68:71], v[100:103], a[80:83], v[68:71]
    ds_read_b64_tr_b16 a[90:91], v236 offset:19456
    v_mfma_f32_16x16x32_bf16 v[28:31], a[72:75], v[100:103], v[28:31]
    buffer_load_dwordx4 v12, s[12:15], s71 offen offset:1024 lds
    ds_read_b64_tr_b16 a[92:93], v236 offset:14336
    v_mfma_f32_16x16x32_bf16 v[224:227], a[72:75], v[136:139], v[224:227]
    buffer_load_dwordx4 v12, s[12:15], s71 offen offset:2048 lds
    ds_read_b64_tr_b16 a[94:95], v236 offset:20480
    v_mfma_f32_16x16x32_bf16 v[32:35], a[76:79], v[84:87], v[32:35]
    v_mfma_f32_16x16x32_bf16 v[52:55], v[84:87], a[80:83], v[52:55]
    s_add_u32 s80, s80, 64
    v_mfma_f32_16x16x32_bf16 v[196:199], v[136:139], v[124:127], v[196:199]
    s_and_b32 s80, s80, 1023
    v_mfma_f32_16x16x32_bf16 v[200:203], v[124:127], v[124:127], v[200:203]
    s_waitcnt lgkmcnt(0)
    s_waitcnt vmcnt(14)
    s_barrier
    v_cndmask_b32 v104, v104, v136, s[84:85]
    v_cndmask_b32 v105, v105, v136, s[84:85]
    v_cndmask_b32 v106, v106, v136, s[84:85]
    v_cndmask_b32 v107, v107, v136, s[84:85]
    v_mfma_f32_16x16x32_bf16 v[36:39], a[88:91], v[108:111], v[36:39]
    ds_read_b128 v[84:87], v5 offset:0
    v_mfma_f32_16x16x32_bf16 v[56:59], v[108:111], a[92:95], v[56:59]
    s_add_u32 m0, s65, 62464
    ds_read_b128 v[88:91], v5 offset:1024
    v_mfma_f32_16x16x32_bf16 v[16:19], a[84:87], v[108:111], v[16:19]
    buffer_load_dwordx4 v140, s[8:11], s83 offen lds
    ds_read_b128 v[92:95], v5 offset:2048
    v_mfma_f32_16x16x32_bf16 v[40:43], a[88:91], v[112:115], v[40:43]
    s_add_u32 s70, s83, s82
    ds_read_b128 v[96:99], v5 offset:3072
    v_mfma_f32_16x16x32_bf16 v[60:63], v[112:115], a[92:95], v[60:63]
    s_and_b32 s70, s70, 1023
    ds_read_b128 v[100:103], v5 offset:4096
    v_mfma_f32_16x16x32_bf16 v[20:23], a[84:87], v[112:115], v[20:23]
    s_add_u32 m0, s67, 61440
    ds_read_b128 v[124:127], v7 offset:0
    v_mfma_f32_16x16x32_bf16 v[44:47], a[88:91], v[116:119], v[44:47]
    ds_read_b64_tr_b16 a[96:97], v236 offset:24576
    v_mfma_f32_16x16x32_bf16 v[64:67], v[116:119], a[92:95], v[64:67]
    buffer_load_dwordx4 v11, s[8:11], s70 offen lds
    ds_read_b64_tr_b16 a[98:99], v236 offset:30720
    v_mfma_f32_16x16x32_bf16 v[24:27], a[84:87], v[116:119], v[24:27]
    s_add_u32 s83, s83, 64
    ds_read_b64_tr_b16 a[100:101], v236 offset:25600
    v_mfma_f32_16x16x32_bf16 v[48:51], a[88:91], v[120:123], v[48:51]
    s_and_b32 s83, s83, 1023
    ds_read_b64_tr_b16 a[102:103], v236 offset:31744
    v_mfma_f32_16x16x32_bf16 v[68:71], v[120:123], a[92:95], v[68:71]
    s_mul_i32 s71, s80, 1536
    ds_read_b64_tr_b16 a[104:105], v236 offset:26624
    v_mfma_f32_16x16x32_bf16 v[28:31], a[84:87], v[120:123], v[28:31]
    s_add_u32 m0, s81, 81920
    ds_read_b64_tr_b16 a[106:107], v236 offset:32768
    v_mfma_f32_16x16x32_bf16 v[224:227], a[84:87], v[136:139], v[224:227]
    v_mfma_f32_16x16x32_bf16 v[32:35], a[88:91], v[104:107], v[32:35]
    buffer_load_dwordx4 v12, s[12:15], s71 offen offset:0 lds
    v_mfma_f32_16x16x32_bf16 v[52:55], v[104:107], a[92:95], v[52:55]
    buffer_load_dwordx4 v12, s[12:15], s71 offen offset:1024 lds
    v_mfma_f32_16x16x32_bf16 v[196:199], v[136:139], v[128:131], v[196:199]
    buffer_load_dwordx4 v12, s[12:15], s71 offen offset:2048 lds
    v_mfma_f32_16x16x32_bf16 v[200:203], v[128:131], v[128:131], v[200:203]
    s_add_u32 s80, s80, 64
    v_mfma_f32_16x16x32_bf16 v[204:207], v[136:139], v[132:135], v[204:207]
    s_and_b32 s80, s80, 1023
    v_mfma_f32_16x16x32_bf16 v[208:211], v[132:135], v[132:135], v[208:211]
    s_waitcnt lgkmcnt(0)
    s_waitcnt vmcnt(15)
    s_barrier
    v_cndmask_b32 v84, v84, v136, s[84:85]
    v_cndmask_b32 v85, v85, v136, s[84:85]
    v_cndmask_b32 v86, v86, v136, s[84:85]
    v_cndmask_b32 v87, v87, v136, s[84:85]
    v_mfma_f32_16x16x32_bf16 v[36:39], a[100:103], v[88:91], v[36:39]
    ds_read_b128 v[104:107], v5 offset:5120
    v_mfma_f32_16x16x32_bf16 v[56:59], v[88:91], a[104:107], v[56:59]
    s_add_u32 m0, s65, 67584
    ds_read_b128 v[108:111], v5 offset:6144
    v_mfma_f32_16x16x32_bf16 v[16:19], a[96:99], v[88:91], v[16:19]
    buffer_load_dwordx4 v140, s[8:11], s83 offen lds
    ds_read_b128 v[112:115], v5 offset:7168
    v_mfma_f32_16x16x32_bf16 v[40:43], a[100:103], v[92:95], v[40:43]
    ds_read_b128 v[116:119], v5 offset:8192
    v_mfma_f32_16x16x32_bf16 v[60:63], v[92:95], a[104:107], v[60:63]
    s_add_u32 s83, s83, 64
    ds_read_b128 v[120:123], v5 offset:9216
    v_mfma_f32_16x16x32_bf16 v[20:23], a[96:99], v[92:95], v[20:23]
    s_and_b32 s83, s83, 1023
    ds_read_b128 v[128:131], v7 offset:5120
    v_mfma_f32_16x16x32_bf16 v[44:47], a[100:103], v[96:99], v[44:47]
    ds_read_b64_tr_b16 a[108:109], v237 offset:0
    v_mfma_f32_16x16x32_bf16 v[64:67], v[96:99], a[104:107], v[64:67]
    s_mul_i32 s71, s80, 1536
    ds_read_b64_tr_b16 a[110:111], v237 offset:6144
    v_mfma_f32_16x16x32_bf16 v[24:27], a[96:99], v[96:99], v[24:27]
    s_add_u32 m0, s81, 94208
    ds_read_b64_tr_b16 a[112:113], v237 offset:1024
    v_mfma_f32_16x16x32_bf16 v[48:51], a[100:103], v[100:103], v[48:51]
    buffer_load_dwordx4 v12, s[12:15], s71 offen offset:0 lds
    ds_read_b64_tr_b16 a[114:115], v237 offset:7168
    v_mfma_f32_16x16x32_bf16 v[68:71], v[100:103], a[104:107], v[68:71]
    ds_read_b64_tr_b16 a[116:117], v237 offset:2048
    v_mfma_f32_16x16x32_bf16 v[28:31], a[96:99], v[100:103], v[28:31]
    buffer_load_dwordx4 v12, s[12:15], s71 offen offset:1024 lds
    ds_read_b64_tr_b16 a[118:119], v237 offset:8192
    v_mfma_f32_16x16x32_bf16 v[224:227], a[96:99], v[136:139], v[224:227]
    buffer_load_dwordx4 v12, s[12:15], s71 offen offset:2048 lds
    v_mfma_f32_16x16x32_bf16 v[32:35], a[100:103], v[84:87], v[32:35]
    v_mfma_f32_16x16x32_bf16 v[52:55], v[84:87], a[104:107], v[52:55]
    s_add_u32 s80, s80, 64
    v_mfma_f32_16x16x32_bf16 v[196:199], v[136:139], v[124:127], v[196:199]
    s_and_b32 s80, s80, 1023
    v_mfma_f32_16x16x32_bf16 v[200:203], v[124:127], v[124:127], v[200:203]
    s_waitcnt lgkmcnt(0)
    s_waitcnt vmcnt(13)
    s_barrier
    v_cndmask_b32 v104, v104, v136, s[84:85]
    v_cndmask_b32 v105, v105, v136, s[84:85]
    v_cndmask_b32 v106, v106, v136, s[84:85]
    v_cndmask_b32 v107, v107, v136, s[84:85]
    v_mfma_f32_16x16x32_bf16 v[36:39], a[112:115], v[108:111], v[36:39]
    ds_read_b128 v[84:87], v5 offset:10240
    v_mfma_f32_16x16x32_bf16 v[56:59], v[108:111], a[116:119], v[56:59]
    s_add_u32 m0, s65, 72704
    ds_read_b128 v[88:91], v5 offset:11264
    v_mfma_f32_16x16x32_bf16 v[16:19], a[108:111], v[108:111], v[16:19]
    buffer_load_dwordx4 v140, s[8:11], s83 offen lds
    ds_read_b128 v[92:95], v5 offset:12288
    v_mfma_f32_16x16x32_bf16 v[40:43], a[112:115], v[112:115], v[40:43]
    ds_read_b128 v[96:99], v5 offset:13312
    v_mfma_f32_16x16x32_bf16 v[60:63], v[112:115], a[116:119], v[60:63]
    s_add_u32 s83, s83, 64
    ds_read_b128 v[100:103], v5 offset:14336
    v_mfma_f32_16x16x32_bf16 v[20:23], a[108:111], v[112:115], v[20:23]
    s_and_b32 s83, s83, 1023
    ds_read_b128 v[124:127], v7 offset:10240
    v_mfma_f32_16x16x32_bf16 v[44:47], a[112:115], v[116:119], v[44:47]
    ds_read_b64_tr_b16 a[120:121], v237 offset:12288
    v_mfma_f32_16x16x32_bf16 v[64:67], v[116:119], a[116:119], v[64:67]
    s_mul_i32 s71, s80, 1536
    ds_read_b64_tr_b16 a[122:123], v237 offset:18432
    v_mfma_f32_16x16x32_bf16 v[24:27], a[108:111], v[116:119], v[24:27]
    s_add_u32 m0, s81, 106496
    ds_read_b64_tr_b16 a[124:125], v237 offset:13312
    v_mfma_f32_16x16x32_bf16 v[48:51], a[112:115], v[120:123], v[48:51]
    buffer_load_dwordx4 v12, s[12:15], s71 offen offset:0 lds
    ds_read_b64_tr_b16 a[126:127], v237 offset:19456
    v_mfma_f32_16x16x32_bf16 v[68:71], v[120:123], a[116:119], v[68:71]
    ds_read_b64_tr_b16 a[128:129], v237 offset:14336
    v_mfma_f32_16x16x32_bf16 v[28:31], a[108:111], v[120:123], v[28:31]
    buffer_load_dwordx4 v12, s[12:15], s71 offen offset:1024 lds
    ds_read_b64_tr_b16 a[130:131], v237 offset:20480
    v_mfma_f32_16x16x32_bf16 v[224:227], a[108:111], v[136:139], v[224:227]
    buffer_load_dwordx4 v12, s[12:15], s71 offen offset:2048 lds
    v_mfma_f32_16x16x32_bf16 v[32:35], a[112:115], v[104:107], v[32:35]
    v_mfma_f32_16x16x32_bf16 v[52:55], v[104:107], a[116:119], v[52:55]
    s_add_u32 s80, s80, 64
    v_mfma_f32_16x16x32_bf16 v[196:199], v[136:139], v[128:131], v[196:199]
    s_and_b32 s80, s80, 1023
    v_mfma_f32_16x16x32_bf16 v[200:203], v[128:131], v[128:131], v[200:203]
    s_waitcnt lgkmcnt(0)
    s_waitcnt vmcnt(13)
    s_barrier
    v_readfirstlane_b32 s78, v220
    v_readfirstlane_b32 s79, v221
    s_nop 0
    s_cmp_eq_u32 s79, 0
    s_cbranch_scc1 L_s1_defer
    s_cmp_lg_u32 s3, 0
    s_cbranch_scc1 L_sig_1
    s_lshl_b32 s61, s7, 5
    v_add_u32 v14, s61, v1
    v_lshlrev_b32 v14, 15, v14
    s_lshl_b32 s61, s4, 7
    s_add_u32 s61, s61, 16777280
    v_add_u32 v14, s61, v14
    v_mov_b32 v222, s78
    v_mov_b32 v223, s79
    s_mov_b32 exec_lo, 0xffffffff
    s_mov_b32 exec_hi, 0
    buffer_store_dwordx2 v[222:223], v14, s[40:43], 0 offen sc1
    s_mov_b64 exec, -1
    s_nop 1
L_sig_1:
    s_cmp_lg_u32 s3, 0
    s_cbranch_scc1 L_id_2
    s_lshl_b32 s61, s4, 3
    v_add_u32 v14, s61, v1
    v_and_b32 v15, 8, v1
    v_lshlrev_b32 v13, 1, v15
    v_sub_u32 v14, v14, v13
    v_lshlrev_b32 v14, 15, v14
    v_lshl_add_u32 v14, v15, 7, v14
    s_lshl_b32 s61, s5, 7
    s_add_u32 s61, s61, 16777312
    v_add_u32 v14, s61, v14
    v_mov_b32 v216, s78
    v_mov_b32 v217, s79
    v_mov_b32 v218, s77
    v_mov_b32 v219, 0
    s_mov_b32 s62, 0xffff
    s_cmp_eq_u32 s4, 0
    s_cselect_b32 exec_lo, 0xff, s62
    s_mov_b32 exec_hi, 0
    buffer_store_dwordx4 v[216:219], v14, s[40:43], 0 offen sc1
    s_mov_b64 exec, -1
    s_nop 1
L_id_2:
L_s1_defer:
    v_cndmask_b32 v84, v84, v136, s[84:85]
    v_cndmask_b32 v85, v85, v136, s[84:85]
    v_cndmask_b32 v86, v86, v136, s[84:85]
    v_cndmask_b32 v87, v87, v136, s[84:85]
    v_mfma_f32_16x16x32_bf16 v[36:39], a[124:127], v[88:91], v[36:39]
    s_add_u32 m0, s65, 77824
    ds_read_b128 v[104:107], v5 offset:15360
    v_mfma_f32_16x16x32_bf16 v[56:59], v[88:91], a[128:131], v[56:59]
    buffer_load_dwordx4 v140, s[8:11], s83 offen lds
    s_add_u32 s83, s83, 64
    ds_read_b128 v[108:111], v5 offset:16384
    v_mfma_f32_16x16x32_bf16 v[16:19], a[120:123], v[88:91], v[16:19]
    s_and_b32 s83, s83, 1023
    s_mul_i32 s71, s80, 1536
    ds_read_b128 v[112:115], v5 offset:17408
    v_mfma_f32_16x16x32_bf16 v[40:43], a[124:127], v[92:95], v[40:43]
    s_add_u32 m0, s81, 118784
    s_nop 0
    buffer_load_dwordx4 v12, s[12:15], s71 offen offset:0 lds
    ds_read_b128 v[116:119], v5 offset:18432
    v_mfma_f32_16x16x32_bf16 v[60:63], v[92:95], a[128:131], v[60:63]
    buffer_load_dwordx4 v12, s[12:15], s71 offen offset:1024 lds
    buffer_load_dwordx4 v12, s[12:15], s71 offen offset:2048 lds
    ds_read_b128 v[120:123], v5 offset:19456
    v_mfma_f32_16x16x32_bf16 v[20:23], a[120:123], v[92:95], v[20:23]
    s_add_u32 s80, s80, 64
    s_and_b32 s80, s80, 1023
    ds_read_b128 v[128:131], v7 offset:15360
    v_mfma_f32_16x16x32_bf16 v[44:47], a[124:127], v[96:99], v[44:47]
    s_lshl_b32 s71, s80, 9
    s_add_u32 m0, s65, 0
    ds_read_b128 v[132:135], v8 offset:40960
    v_mfma_f32_16x16x32_bf16 v[64:67], v[96:99], a[128:131], v[64:67]
    buffer_load_dwordx4 v238, s[16:19], s71 offen lds
    s_add_u32 s80, s80, 64
    ds_read_b64_tr_b16 a[132:133], v237 offset:24576
    v_mfma_f32_16x16x32_bf16 v[24:27], a[120:123], v[96:99], v[24:27]
    s_and_b32 s80, s80, 1023
    ds_read_b64_tr_b16 a[134:135], v237 offset:30720
    v_mfma_f32_16x16x32_bf16 v[48:51], a[124:127], v[100:103], v[48:51]
    s_lshl_b32 s71, s80, 9
    s_add_u32 m0, s65, 4096
    ds_read_b64_tr_b16 a[136:137], v237 offset:25600
    v_mfma_f32_16x16x32_bf16 v[68:71], v[100:103], a[128:131], v[68:71]
    buffer_load_dwordx4 v238, s[16:19], s71 offen lds
    s_add_u32 s80, s80, 64
    ds_read_b64_tr_b16 a[138:139], v237 offset:31744
    v_mfma_f32_16x16x32_bf16 v[28:31], a[120:123], v[100:103], v[28:31]
    s_and_b32 s80, s80, 1023
    s_lshl_b32 s71, s80, 9
    ds_read_b64_tr_b16 a[140:141], v237 offset:26624
    v_mfma_f32_16x16x32_bf16 v[224:227], a[120:123], v[136:139], v[224:227]
    s_add_u32 m0, s65, 8192
    s_nop 0
    buffer_load_dwordx4 v238, s[16:19], s71 offen lds
    ds_read_b64_tr_b16 a[142:143], v237 offset:32768
    v_mfma_f32_16x16x32_bf16 v[32:35], a[124:127], v[84:87], v[32:35]
    s_add_u32 s80, s80, 64
    s_and_b32 s80, s80, 1023
    v_mfma_f32_16x16x32_bf16 v[52:55], v[84:87], a[128:131], v[52:55]
    s_lshl_b32 s71, s80, 9
    s_add_u32 m0, s65, 12288
    v_mfma_f32_16x16x32_bf16 v[196:199], v[136:139], v[124:127], v[196:199]
    buffer_load_dwordx4 v238, s[16:19], s71 offen lds
    s_add_u32 s80, s80, 64
    v_mfma_f32_16x16x32_bf16 v[200:203], v[124:127], v[124:127], v[200:203]
    s_and_b32 s80, s80, 1023
    s_waitcnt lgkmcnt(0)
    s_waitcnt vmcnt(16)
    s_barrier
    v_cndmask_b32 v104, v104, v136, s[84:85]
    v_cndmask_b32 v105, v105, v136, s[84:85]
    v_cndmask_b32 v106, v106, v136, s[84:85]
    v_cndmask_b32 v107, v107, v136, s[84:85]
    v_mfma_f32_16x16x32_bf16 v[36:39], a[136:139], v[108:111], v[36:39]
    s_lshl_b32 s71, s80, 9
    ds_read_b128 v[84:87], v5 offset:20480
    v_mfma_f32_16x16x32_bf16 v[56:59], v[108:111], a[140:143], v[56:59]
    s_add_u32 m0, s65, 16384
    ds_read_b128 v[88:91], v5 offset:21504
    v_mfma_f32_16x16x32_bf16 v[16:19], a[132:135], v[108:111], v[16:19]
    buffer_load_dwordx4 v238, s[16:19], s71 offen lds
    ds_read_b128 v[92:95], v5 offset:22528
    v_mfma_f32_16x16x32_bf16 v[40:43], a[136:139], v[112:115], v[40:43]
    s_add_u32 s80, s80, 64
    ds_read_b128 v[96:99], v5 offset:23552
    v_mfma_f32_16x16x32_bf16 v[60:63], v[112:115], a[140:143], v[60:63]
    s_and_b32 s80, s80, 1023
    ds_read_b128 v[100:103], v5 offset:24576
    v_mfma_f32_16x16x32_bf16 v[20:23], a[132:135], v[112:115], v[20:23]
    s_lshl_b32 s71, s80, 9
    ds_read_b128 v[124:127], v7 offset:20480
    v_mfma_f32_16x16x32_bf16 v[44:47], a[136:139], v[116:119], v[44:47]
    s_add_u32 m0, s65, 20480
    ds_read_b64_tr_b16 a[144:145], v236 offset:0
    v_mfma_f32_16x16x32_bf16 v[64:67], v[116:119], a[140:143], v[64:67]
    buffer_load_dwordx4 v238, s[16:19], s71 offen lds
    ds_read_b64_tr_b16 a[146:147], v236 offset:6144
    v_mfma_f32_16x16x32_bf16 v[24:27], a[132:135], v[116:119], v[24:27]
    s_add_u32 s80, s80, 64
    ds_read_b64_tr_b16 a[148:149], v236 offset:1024
    v_mfma_f32_16x16x32_bf16 v[48:51], a[136:139], v[120:123], v[48:51]
    s_and_b32 s80, s80, 1023
    s_lshl_b32 s71, s80, 9
    ds_read_b64_tr_b16 a[150:151], v236 offset:7168
    v_mfma_f32_16x16x32_bf16 v[68:71], v[120:123], a[140:143], v[68:71]
    s_add_u32 m0, s65, 24576
    ds_read_b64_tr_b16 a[152:153], v236 offset:2048
    v_mfma_f32_16x16x32_bf16 v[28:31], a[132:135], v[120:123], v[28:31]
    buffer_load_dwordx4 v238, s[16:19], s71 offen lds
    ds_read_b64_tr_b16 a[154:155], v236 offset:8192
    v_mfma_f32_16x16x32_bf16 v[224:227], a[132:135], v[136:139], v[224:227]
    s_add_u32 s80, s80, 64
    v_mfma_f32_16x16x32_bf16 v[32:35], a[136:139], v[104:107], v[32:35]
    s_and_b32 s80, s80, 1023
    v_mfma_f32_16x16x32_bf16 v[52:55], v[104:107], a[140:143], v[52:55]
    s_lshl_b32 s71, s80, 9
    v_mfma_f32_16x16x32_bf16 v[196:199], v[136:139], v[128:131], v[196:199]
    s_add_u32 m0, s65, 28672
    v_mfma_f32_16x16x32_bf16 v[200:203], v[128:131], v[128:131], v[200:203]
    buffer_load_dwordx4 v238, s[16:19], s71 offen lds
    v_mfma_f32_16x16x32_bf16 v[204:207], v[136:139], v[132:135], v[204:207]
    s_add_u32 s80, s80, 64
    v_mfma_f32_16x16x32_bf16 v[208:211], v[132:135], v[132:135], v[208:211]
    s_and_b32 s80, s80, 1023
    s_waitcnt lgkmcnt(0)
    s_waitcnt vmcnt(16)
    s_barrier
    v_cndmask_b32 v84, v84, v136, s[84:85]
    v_cndmask_b32 v85, v85, v136, s[84:85]
    v_cndmask_b32 v86, v86, v136, s[84:85]
    v_cndmask_b32 v87, v87, v136, s[84:85]
    v_mfma_f32_16x16x32_bf16 v[36:39], a[148:151], v[88:91], v[36:39]
    s_lshl_b32 s71, s80, 9
    ds_read_b128 v[104:107], v5 offset:25600
    v_mfma_f32_16x16x32_bf16 v[56:59], v[88:91], a[152:155], v[56:59]
    s_add_u32 m0, s65, 32768
    s_nop 0
    buffer_load_dwordx4 v238, s[16:19], s71 offen lds
    ds_read_b128 v[108:111], v5 offset:26624
    v_mfma_f32_16x16x32_bf16 v[16:19], a[144:147], v[88:91], v[16:19]
    s_add_u32 s80, s80, 64
    ds_read_b128 v[112:115], v5 offset:27648
    v_mfma_f32_16x16x32_bf16 v[40:43], a[148:151], v[92:95], v[40:43]
    s_and_b32 s80, s80, 1023
    s_lshl_b32 s71, s80, 9
    ds_read_b128 v[116:119], v5 offset:28672
    v_mfma_f32_16x16x32_bf16 v[60:63], v[92:95], a[152:155], v[60:63]
    s_add_u32 m0, s65, 36864
    s_nop 0
    buffer_load_dwordx4 v238, s[16:19], s71 offen lds
    ds_read_b128 v[120:123], v5 offset:29696
    v_mfma_f32_16x16x32_bf16 v[20:23], a[144:147], v[92:95], v[20:23]
    s_add_u32 s80, s80, 64
    ds_read_b128 v[128:131], v7 offset:25600
    v_mfma_f32_16x16x32_bf16 v[44:47], a[148:151], v[96:99], v[44:47]
    s_and_b32 s80, s80, 1023
    s_lshl_b32 s71, s80, 9
    ds_read_b64_tr_b16 a[156:157], v236 offset:12288
    v_mfma_f32_16x16x32_bf16 v[64:67], v[96:99], a[152:155], v[64:67]
    s_add_u32 m0, s65, 40960
    s_nop 0
    buffer_load_dwordx4 v238, s[16:19], s71 offen lds
    ds_read_b64_tr_b16 a[158:159], v236 offset:18432
    v_mfma_f32_16x16x32_bf16 v[24:27], a[144:147], v[96:99], v[24:27]
    s_add_u32 s80, s80, 64
    ds_read_b64_tr_b16 a[160:161], v236 offset:13312
    v_mfma_f32_16x16x32_bf16 v[48:51], a[148:151], v[100:103], v[48:51]
    s_and_b32 s80, s80, 1023
    s_lshl_b32 s71, s80, 9
    ds_read_b64_tr_b16 a[162:163], v236 offset:19456
    v_mfma_f32_16x16x32_bf16 v[68:71], v[100:103], a[152:155], v[68:71]
    s_add_u32 m0, s65, 45056
    s_nop 0
    buffer_load_dwordx4 v238, s[16:19], s71 offen lds
    ds_read_b64_tr_b16 a[164:165], v236 offset:14336
    v_mfma_f32_16x16x32_bf16 v[28:31], a[144:147], v[100:103], v[28:31]
    s_add_u32 s80, s80, 64
    ds_read_b64_tr_b16 a[166:167], v236 offset:20480
    v_mfma_f32_16x16x32_bf16 v[224:227], a[144:147], v[136:139], v[224:227]
    s_and_b32 s80, s80, 1023
    v_lshlrev_b32 v13, 4, v0
    v_mfma_f32_16x16x32_bf16 v[32:35], a[148:151], v[84:87], v[32:35]
    s_lshl_b32 s70, s60, 13
    buffer_load_dwordx4 v[144:147], v13, s[28:31], s70 offen
    v_mfma_f32_16x16x32_bf16 v[52:55], v[84:87], a[152:155], v[52:55]
    buffer_load_dword v148, v13, s[28:31], s70 offen offset:16
    v_mfma_f32_16x16x32_bf16 v[196:199], v[136:139], v[124:127], v[196:199]
    s_add_u32 s70, s70, 4096
    buffer_load_dwordx4 v[152:155], v13, s[28:31], s70 offen
    v_mfma_f32_16x16x32_bf16 v[200:203], v[124:127], v[124:127], v[200:203]
    buffer_load_dword v156, v13, s[28:31], s70 offen offset:16
    s_waitcnt lgkmcnt(0)
    s_waitcnt vmcnt(20)
    s_barrier
    v_cndmask_b32 v104, v104, v136, s[84:85]
    v_cndmask_b32 v105, v105, v136, s[84:85]
    v_cndmask_b32 v106, v106, v136, s[84:85]
    v_cndmask_b32 v107, v107, v136, s[84:85]
    v_mfma_f32_16x16x32_bf16 v[36:39], a[160:163], v[108:111], v[36:39]
    ds_read_b128 v[84:87], v5 offset:30720
    v_mfma_f32_16x16x32_bf16 v[56:59], v[108:111], a[164:167], v[56:59]
    s_lshl_b32 s71, s80, 9
    ds_read_b128 v[88:91], v5 offset:31744
    v_mfma_f32_16x16x32_bf16 v[16:19], a[156:159], v[108:111], v[16:19]
    s_add_u32 m0, s65, 49152
    ds_read_b128 v[92:95], v5 offset:32768
    v_mfma_f32_16x16x32_bf16 v[40:43], a[160:163], v[112:115], v[40:43]
    buffer_load_dwordx4 v238, s[16:19], s71 offen lds
    ds_read_b128 v[96:99], v5 offset:33792
    v_mfma_f32_16x16x32_bf16 v[60:63], v[112:115], a[164:167], v[60:63]
    s_add_u32 s80, s80, 64
    ds_read_b128 v[100:103], v5 offset:34816
    v_mfma_f32_16x16x32_bf16 v[20:23], a[156:159], v[112:115], v[20:23]
    s_and_b32 s80, s80, 1023
    ds_read_b128 v[124:127], v7 offset:30720
    v_mfma_f32_16x16x32_bf16 v[44:47], a[160:163], v[116:119], v[44:47]
    s_lshl_b32 s71, s80, 9
    ds_read_b64_tr_b16 a[168:169], v236 offset:24576
    v_mfma_f32_16x16x32_bf16 v[64:67], v[116:119], a[164:167], v[64:67]
    s_add_u32 m0, s65, 53248
    ds_read_b64_tr_b16 a[170:171], v236 offset:30720
    v_mfma_f32_16x16x32_bf16 v[24:27], a[156:159], v[116:119], v[24:27]
    buffer_load_dwordx4 v238, s[16:19], s71 offen lds
    ds_read_b64_tr_b16 a[172:173], v236 offset:25600
    v_mfma_f32_16x16x32_bf16 v[48:51], a[160:163], v[120:123], v[48:51]
    s_add_u32 s80, s80, 64
    ds_read_b64_tr_b16 a[174:175], v236 offset:31744
    v_mfma_f32_16x16x32_bf16 v[68:71], v[120:123], a[164:167], v[68:71]
    s_and_b32 s80, s80, 1023
    ds_read_b64_tr_b16 a[176:177], v236 offset:26624
    v_mfma_f32_16x16x32_bf16 v[28:31], a[156:159], v[120:123], v[28:31]
    s_lshl_b32 s71, s80, 9
    ds_read_b64_tr_b16 a[178:179], v236 offset:32768
    v_mfma_f32_16x16x32_bf16 v[224:227], a[156:159], v[136:139], v[224:227]
    s_add_u32 m0, s65, 57344
    v_mfma_f32_16x16x32_bf16 v[32:35], a[160:163], v[104:107], v[32:35]
    buffer_load_dwordx4 v238, s[16:19], s71 offen lds
    v_mfma_f32_16x16x32_bf16 v[52:55], v[104:107], a[164:167], v[52:55]
    s_add_u32 s80, s80, 64
    v_mfma_f32_16x16x32_bf16 v[196:199], v[136:139], v[128:131], v[196:199]
    s_and_b32 s80, s80, 1023
    v_mfma_f32_16x16x32_bf16 v[200:203], v[128:131], v[128:131], v[200:203]
    s_waitcnt lgkmcnt(0)
    s_waitcnt vmcnt(19)
    s_barrier
    v_cndmask_b32 v84, v84, v136, s[84:85]
    v_cndmask_b32 v85, v85, v136, s[84:85]
    v_cndmask_b32 v86, v86, v136, s[84:85]
    v_cndmask_b32 v87, v87, v136, s[84:85]
    v_mfma_f32_16x16x32_bf16 v[36:39], a[172:175], v[88:91], v[36:39]
    ds_read_b128 v[104:107], v5 offset:35840
    v_mfma_f32_16x16x32_bf16 v[56:59], v[88:91], a[176:179], v[56:59]
    ds_read_b128 v[108:111], v5 offset:36864
    v_mfma_f32_16x16x32_bf16 v[16:19], a[168:171], v[88:91], v[16:19]
    ds_read_b128 v[112:115], v5 offset:37888
    v_mfma_f32_16x16x32_bf16 v[40:43], a[172:175], v[92:95], v[40:43]
    ds_read_b128 v[116:119], v5 offset:38912
    v_mfma_f32_16x16x32_bf16 v[60:63], v[92:95], a[176:179], v[60:63]
    ds_read_b128 v[120:123], v5 offset:39936
    v_mfma_f32_16x16x32_bf16 v[20:23], a[168:171], v[92:95], v[20:23]
    ds_read_b128 v[128:131], v7 offset:35840
    v_mfma_f32_16x16x32_bf16 v[44:47], a[172:175], v[96:99], v[44:47]
    ds_read_b128 v[132:135], v8 offset:61440
    v_mfma_f32_16x16x32_bf16 v[64:67], v[96:99], a[176:179], v[64:67]
    ds_read_b64_tr_b16 a[180:181], v237 offset:0
    v_mfma_f32_16x16x32_bf16 v[24:27], a[168:171], v[96:99], v[24:27]
    ds_read_b64_tr_b16 a[182:183], v237 offset:6144
    v_mfma_f32_16x16x32_bf16 v[48:51], a[172:175], v[100:103], v[48:51]
    ds_read_b64_tr_b16 a[184:185], v237 offset:1024
    v_mfma_f32_16x16x32_bf16 v[68:71], v[100:103], a[176:179], v[68:71]
    ds_read_b64_tr_b16 a[186:187], v237 offset:7168
    v_mfma_f32_16x16x32_bf16 v[28:31], a[168:171], v[100:103], v[28:31]
    ds_read_b64_tr_b16 a[188:189], v237 offset:2048
    v_mfma_f32_16x16x32_bf16 v[224:227], a[168:171], v[136:139], v[224:227]
    ds_read_b64_tr_b16 a[190:191], v237 offset:8192
    v_mfma_f32_16x16x32_bf16 v[32:35], a[172:175], v[84:87], v[32:35]
    v_mfma_f32_16x16x32_bf16 v[52:55], v[84:87], a[176:179], v[52:55]
    v_mfma_f32_16x16x32_bf16 v[196:199], v[136:139], v[124:127], v[196:199]
    v_mfma_f32_16x16x32_bf16 v[200:203], v[124:127], v[124:127], v[200:203]
    s_waitcnt lgkmcnt(0)
    s_barrier
    s_lshl_b32 s71, s80, 9
    s_add_u32 m0, s65, 61440
    s_nop 0
    buffer_load_dwordx4 v238, s[16:19], s71 offen lds
    s_add_u32 s80, s80, 64
    s_and_b32 s80, s80, 1023
    v_cndmask_b32 v104, v104, v136, s[84:85]
    v_cndmask_b32 v105, v105, v136, s[84:85]
    v_cndmask_b32 v106, v106, v136, s[84:85]
    v_cndmask_b32 v107, v107, v136, s[84:85]
    v_mfma_f32_16x16x32_bf16 v[36:39], a[184:187], v[108:111], v[36:39]
    v_mfma_f32_16x16x32_bf16 v[56:59], v[108:111], a[188:191], v[56:59]
    v_mfma_f32_16x16x32_bf16 v[16:19], a[180:183], v[108:111], v[16:19]
    v_mfma_f32_16x16x32_bf16 v[40:43], a[184:187], v[112:115], v[40:43]
    v_mfma_f32_16x16x32_bf16 v[60:63], v[112:115], a[188:191], v[60:63]
    v_mfma_f32_16x16x32_bf16 v[20:23], a[180:183], v[112:115], v[20:23]
    v_mfma_f32_16x16x32_bf16 v[44:47], a[184:187], v[116:119], v[44:47]
    v_mfma_f32_16x16x32_bf16 v[64:67], v[116:119], a[188:191], v[64:67]
    v_mfma_f32_16x16x32_bf16 v[24:27], a[180:183], v[116:119], v[24:27]
    v_mfma_f32_16x16x32_bf16 v[48:51], a[184:187], v[120:123], v[48:51]
    v_mfma_f32_16x16x32_bf16 v[68:71], v[120:123], a[188:191], v[68:71]
    v_mfma_f32_16x16x32_bf16 v[28:31], a[180:183], v[120:123], v[28:31]
    v_mfma_f32_16x16x32_bf16 v[224:227], a[180:183], v[136:139], v[224:227]
    v_mfma_f32_16x16x32_bf16 v[32:35], a[184:187], v[104:107], v[32:35]
    v_mfma_f32_16x16x32_bf16 v[52:55], v[104:107], a[188:191], v[52:55]
    v_mfma_f32_16x16x32_bf16 v[196:199], v[136:139], v[128:131], v[196:199]
    v_mfma_f32_16x16x32_bf16 v[200:203], v[128:131], v[128:131], v[200:203]
    v_mfma_f32_16x16x32_bf16 v[204:207], v[136:139], v[132:135], v[204:207]
    v_mfma_f32_16x16x32_bf16 v[208:211], v[132:135], v[132:135], v[208:211]
    s_cmp_lg_u32 s79, 0
    s_cbranch_scc1 L_nonce_ok
    v_mov_b32 v13, 0
    s_nop 4
L_nonce_chk:
    buffer_load_dwordx2 v[220:221], v13, s[36:39], 0 offen sc1
    s_waitcnt vmcnt(0)
    v_readfirstlane_b32 s78, v220
    v_readfirstlane_b32 s79, v221
    s_nop 0
    s_cmp_eq_u32 s79, 0
    s_cbranch_scc1 L_nonce_chk
    s_cmp_lg_u32 s3, 0
    s_cbranch_scc1 L_sig_3
    s_lshl_b32 s61, s7, 5
    v_add_u32 v14, s61, v1
    v_lshlrev_b32 v14, 15, v14
    s_lshl_b32 s61, s4, 7
    s_add_u32 s61, s61, 16777280
    v_add_u32 v14, s61, v14
    v_mov_b32 v222, s78
    v_mov_b32 v223, s79
    s_mov_b32 exec_lo, 0xffffffff
    s_mov_b32 exec_hi, 0
    buffer_store_dwordx2 v[222:223], v14, s[40:43], 0 offen sc1
    s_mov_b64 exec, -1
    s_nop 1
L_sig_3:
    s_cmp_lg_u32 s3, 0
    s_cbranch_scc1 L_id_4
    s_lshl_b32 s61, s4, 3
    v_add_u32 v14, s61, v1
    v_and_b32 v15, 8, v1
    v_lshlrev_b32 v13, 1, v15
    v_sub_u32 v14, v14, v13
    v_lshlrev_b32 v14, 15, v14
    v_lshl_add_u32 v14, v15, 7, v14
    s_lshl_b32 s61, s5, 7
    s_add_u32 s61, s61, 16777312
    v_add_u32 v14, s61, v14
    v_mov_b32 v216, s78
    v_mov_b32 v217, s79
    v_mov_b32 v218, s77
    v_mov_b32 v219, 0
    s_mov_b32 s62, 0xffff
    s_cmp_eq_u32 s4, 0
    s_cselect_b32 exec_lo, 0xff, s62
    s_mov_b32 exec_hi, 0
    buffer_store_dwordx4 v[216:219], v14, s[40:43], 0 offen sc1
    s_mov_b64 exec, -1
    s_nop 1
L_id_4:
L_nonce_ok:
    v_and_b32 v13, 48, v1
    v_lshlrev_b32 v13, 2, v13
    v_lshlrev_b32 v14, 2, v2
    ds_bpermute_b32 v228, v13, v32
    ds_bpermute_b32 v229, v13, v33
    ds_bpermute_b32 v230, v13, v34
    ds_bpermute_b32 v231, v13, v35
    ds_bpermute_b32 v232, v14, v52
    s_lshl_b32 s70, s3, 11
    v_lshlrev_b32 v13, 3, v2
    s_lshl_b32 s61, s3, 7
    v_add_u32 v13, s61, v13
    v_add_u32 v13, 91392, v13
    s_mov_b32 s72, 0x22222222
    s_mov_b32 s73, 0x22222222
    v_cndmask_b32 v197, v200, v201, s[72:73]
    v_cndmask_b32 v205, v208, v209, s[72:73]
    s_mov_b32 s72, 0x44444444
    s_mov_b32 s73, 0x44444444
    v_cndmask_b32 v197, v197, v202, s[72:73]
    v_cndmask_b32 v205, v205, v210, s[72:73]
    s_mov_b32 s72, 0x88888888
    s_mov_b32 s73, 0x88888888
    v_cndmask_b32 v197, v197, v203, s[72:73]
    s_add_u32 s70, s70, s68
    v_cndmask_b32 v205, v205, v211, s[72:73]
    s_mov_b32 exec_lo, 0x00f0000f
    s_mov_b32 exec_hi, 0xf0000f00
    ds_write_b64 v13, v[196:197]
    ds_write_b64 v13, v[204:205] offset:512
    s_mov_b64 exec, -1
    v_lshlrev_b32 v13, 3, v1
    v_add_u32 v13, 91392, v13
    v_lshlrev_b32 v14, 3, v2
    v_add_u32 v14, 91392, v14
    s_waitcnt lgkmcnt(0)
    s_barrier
    ds_read_b64 v[84:85], v13
    ds_read_b64 v[86:87], v14 offset:512
    ds_read_b64 v[88:89], v14 offset:640
    s_add_u32 s70, s70, 4096
    ds_read_b64 v[90:91], v14 offset:768
    ds_read_b64 v[92:93], v14 offset:896
    s_mul_i32 s61, s3, 640
    s_add_u32 s61, s61, 92416
    v_lshl_add_u32 v13, v1, 2, s61
    v_lshl_add_u32 v14, v2, 2, s61
    v_lshl_add_u32 v15, v3, 4, s61
    s_waitcnt lgkmcnt(0)
    v_pk_add_f32 v[86:87], v[86:87], v[88:89]
    v_pk_add_f32 v[90:91], v[90:91], v[92:93]
    v_pk_add_f32 v[86:87], v[86:87], v[90:91]
    v_lshlrev_b32 v217, 7, v2
    v_mul_f32 v96, 0x3b000000, v84
    v_mul_f32 v100, 0x3b000000, v86
    v_mul_f32 v97, 0x3b000000, v85
    v_mul_f32 v101, 0x3b000000, v87
    v_fma_f32 v97, -v96, v96, v97
    v_fma_f32 v101, -v100, v100, v101
    v_max_f32 v97, 0, v97
    v_max_f32 v101, 0, v101
    buffer_load_dword v216, v217, s[40:43], s70 offen sc1
    v_cvt_pk_bf16_f32 v96, v96, v97
    v_cvt_pk_bf16_f32 v100, v100, v101
    v_and_b32 v97, 0xffff0000, v96
    v_and_b32 v101, 0xffff0000, v100
    v_lshlrev_b32 v96, 16, v96
    v_lshlrev_b32 v100, 16, v100
    v_add_f32 v97, 0x3727c5ac, v97
    v_add_f32 v101, 0x3727c5ac, v101
    v_cvt_pk_bf16_f32 v97, v97, v97
    v_cvt_pk_bf16_f32 v101, v101, v101
    v_lshlrev_b32 v97, 16, v97
    v_lshlrev_b32 v101, 16, v101
    v_sqrt_f32 v97, v97
    v_sqrt_f32 v101, v101
    v_cvt_pk_bf16_f32 v97, v97, v97
    v_cvt_pk_bf16_f32 v101, v101, v101
    v_lshlrev_b32 v97, 16, v97
    v_lshlrev_b32 v101, 16, v101
    v_rcp_f32 v94, v97
    v_rcp_f32 v98, v101
    v_mul_f32 v95, -v96, v94
    v_mul_f32 v99, -v100, v98
    ds_write2_b32 v13, v94, v95 offset0:16 offset1:96
    ds_write2_b32 v14, v98, v99 offset0:0 offset1:80
    s_mul_i32 s61, s3, 640
    s_add_u32 s61, s61, 92416
    v_lshl_add_u32 v13, v1, 2, s61
    v_lshl_add_u32 v14, v2, 2, s61
    v_lshl_add_u32 v15, v3, 4, s61
    s_waitcnt lgkmcnt(0)
    ds_read2_b32 v[84:85], v14 offset0:0 offset1:80
    ds_read2_b32 v[86:87], v14 offset0:16 offset1:96
    ds_read2_b32 v[88:89], v14 offset0:32 offset1:112
    ds_read2_b32 v[90:91], v14 offset0:48 offset1:128
    ds_read2_b32 v[92:93], v14 offset0:64 offset1:144
    ds_read_b128 v[94:97], v15 offset:0
    ds_read_b128 v[98:101], v15 offset:320
    ds_read_b128 v[102:105], v15 offset:64
    ds_read_b128 v[106:109], v15 offset:384
    ds_read_b128 v[110:113], v15 offset:128
    ds_read_b128 v[114:117], v15 offset:448
    ds_read_b128 v[118:121], v15 offset:192
    ds_read_b128 v[122:125], v15 offset:512
    ds_read_b128 v[126:129], v15 offset:256
    ds_read_b128 v[130:133], v15 offset:576
    s_waitcnt lgkmcnt(10)
    v_pk_mul_f32 v[188:189], v[228:229], v[84:85] op_sel:[0,1] op_sel_hi:[1,1]
    v_pk_fma_f32 v[188:189], v[32:33], v[84:85], v[188:189] op_sel:[0,0,0] op_sel_hi:[1,0,1]
    v_pk_mul_f32 v[190:191], v[230:231], v[84:85] op_sel:[0,1] op_sel_hi:[1,1]
    v_pk_fma_f32 v[190:191], v[34:35], v[84:85], v[190:191] op_sel:[0,0,0] op_sel_hi:[1,0,1]
    v_cvt_pk_bf16_f32 v168, v188, v189
    v_cvt_pk_bf16_f32 v169, v190, v191
    v_pk_mul_f32 v[188:189], v[228:229], v[86:87] op_sel:[0,1] op_sel_hi:[1,1]
    v_pk_fma_f32 v[188:189], v[36:37], v[86:87], v[188:189] op_sel:[0,0,0] op_sel_hi:[1,0,1]
    v_pk_mul_f32 v[190:191], v[230:231], v[86:87] op_sel:[0,1] op_sel_hi:[1,1]
    v_pk_fma_f32 v[190:191], v[38:39], v[86:87], v[190:191] op_sel:[0,0,0] op_sel_hi:[1,0,1]
    v_cvt_pk_bf16_f32 v170, v188, v189
    v_cvt_pk_bf16_f32 v171, v190, v191
    v_pk_mul_f32 v[188:189], v[224:225], v[86:87] op_sel:[0,1] op_sel_hi:[1,1]
    v_pk_fma_f32 v[188:189], v[16:17], v[86:87], v[188:189] op_sel:[0,0,0] op_sel_hi:[1,0,1]
    v_pk_mul_f32 v[190:191], v[226:227], v[86:87] op_sel:[0,1] op_sel_hi:[1,1]
    v_pk_fma_f32 v[190:191], v[18:19], v[86:87], v[190:191] op_sel:[0,0,0] op_sel_hi:[1,0,1]
    v_cvt_pk_bf16_f32 v160, v188, v189
    v_cvt_pk_bf16_f32 v161, v190, v191
    v_pk_mul_f32 v[188:189], v[228:229], v[88:89] op_sel:[0,1] op_sel_hi:[1,1]
    v_pk_fma_f32 v[188:189], v[40:41], v[88:89], v[188:189] op_sel:[0,0,0] op_sel_hi:[1,0,1]
    v_pk_mul_f32 v[190:191], v[230:231], v[88:89] op_sel:[0,1] op_sel_hi:[1,1]
    v_pk_fma_f32 v[190:191], v[42:43], v[88:89], v[190:191] op_sel:[0,0,0] op_sel_hi:[1,0,1]
    v_cvt_pk_bf16_f32 v172, v188, v189
    v_cvt_pk_bf16_f32 v173, v190, v191
    v_pk_mul_f32 v[188:189], v[224:225], v[88:89] op_sel:[0,1] op_sel_hi:[1,1]
    v_pk_fma_f32 v[188:189], v[20:21], v[88:89], v[188:189] op_sel:[0,0,0] op_sel_hi:[1,0,1]
    v_pk_mul_f32 v[190:191], v[226:227], v[88:89] op_sel:[0,1] op_sel_hi:[1,1]
    v_pk_fma_f32 v[190:191], v[22:23], v[88:89], v[190:191] op_sel:[0,0,0] op_sel_hi:[1,0,1]
    v_cvt_pk_bf16_f32 v162, v188, v189
    v_cvt_pk_bf16_f32 v163, v190, v191
    v_pk_mul_f32 v[188:189], v[228:229], v[90:91] op_sel:[0,1] op_sel_hi:[1,1]
    v_pk_fma_f32 v[188:189], v[44:45], v[90:91], v[188:189] op_sel:[0,0,0] op_sel_hi:[1,0,1]
    v_pk_mul_f32 v[190:191], v[230:231], v[90:91] op_sel:[0,1] op_sel_hi:[1,1]
    v_pk_fma_f32 v[190:191], v[46:47], v[90:91], v[190:191] op_sel:[0,0,0] op_sel_hi:[1,0,1]
    v_cvt_pk_bf16_f32 v174, v188, v189
    v_cvt_pk_bf16_f32 v175, v190, v191
    v_pk_mul_f32 v[188:189], v[224:225], v[90:91] op_sel:[0,1] op_sel_hi:[1,1]
    v_pk_fma_f32 v[188:189], v[24:25], v[90:91], v[188:189] op_sel:[0,0,0] op_sel_hi:[1,0,1]
    v_pk_mul_f32 v[190:191], v[226:227], v[90:91] op_sel:[0,1] op_sel_hi:[1,1]
    v_pk_fma_f32 v[190:191], v[26:27], v[90:91], v[190:191] op_sel:[0,0,0] op_sel_hi:[1,0,1]
    v_cvt_pk_bf16_f32 v164, v188, v189
    v_cvt_pk_bf16_f32 v165, v190, v191
    v_pk_mul_f32 v[188:189], v[228:229], v[92:93] op_sel:[0,1] op_sel_hi:[1,1]
    v_pk_fma_f32 v[188:189], v[48:49], v[92:93], v[188:189] op_sel:[0,0,0] op_sel_hi:[1,0,1]
    v_pk_mul_f32 v[190:191], v[230:231], v[92:93] op_sel:[0,1] op_sel_hi:[1,1]
    v_pk_fma_f32 v[190:191], v[50:51], v[92:93], v[190:191] op_sel:[0,0,0] op_sel_hi:[1,0,1]
    v_cvt_pk_bf16_f32 v176, v188, v189
    v_cvt_pk_bf16_f32 v177, v190, v191
    v_pk_mul_f32 v[188:189], v[224:225], v[92:93] op_sel:[0,1] op_sel_hi:[1,1]
    v_pk_fma_f32 v[188:189], v[28:29], v[92:93], v[188:189] op_sel:[0,0,0] op_sel_hi:[1,0,1]
    v_pk_mul_f32 v[190:191], v[226:227], v[92:93] op_sel:[0,1] op_sel_hi:[1,1]
    v_pk_fma_f32 v[190:191], v[30:31], v[92:93], v[190:191] op_sel:[0,0,0] op_sel_hi:[1,0,1]
    v_cvt_pk_bf16_f32 v166, v188, v189
    v_cvt_pk_bf16_f32 v167, v190, v191
    v_mfma_f32_16x16x16_bf16 v[16:19], v[170:171], v[160:161], 0
    v_mfma_f32_16x16x16_bf16 v[32:35], v[168:169], v[160:161], 0
    v_mfma_f32_16x16x16_bf16 v[20:23], v[172:173], v[162:163], 0
    v_mfma_f32_16x16x16_bf16 v[36:39], v[170:171], v[162:163], 0
    v_mfma_f32_16x16x16_bf16 v[24:27], v[174:175], v[164:165], 0
    v_mfma_f32_16x16x16_bf16 v[40:43], v[172:173], v[164:165], 0
    v_mfma_f32_16x16x16_bf16 v[28:31], v[176:177], v[166:167], 0
    v_mfma_f32_16x16x16_bf16 v[44:47], v[174:175], v[166:167], 0
    s_waitcnt lgkmcnt(0)
    v_pk_mul_f32 v[192:193], v[98:99], v[232:233] op_sel:[0,0] op_sel_hi:[1,0]
    v_pk_fma_f32 v[192:193], v[52:53], v[94:95], v[192:193]
    v_pk_mul_f32 v[194:195], v[100:101], v[232:233] op_sel:[0,0] op_sel_hi:[1,0]
    v_pk_fma_f32 v[194:195], v[54:55], v[96:97], v[194:195]
    v_cvt_pk_bf16_f32 v178, v192, v193
    v_cvt_pk_bf16_f32 v179, v194, v195
    v_pk_mul_f32 v[192:193], v[106:107], v[232:233] op_sel:[0,0] op_sel_hi:[1,0]
    v_pk_fma_f32 v[192:193], v[56:57], v[102:103], v[192:193]
    v_pk_mul_f32 v[194:195], v[108:109], v[232:233] op_sel:[0,0] op_sel_hi:[1,0]
    v_pk_fma_f32 v[194:195], v[58:59], v[104:105], v[194:195]
    v_cvt_pk_bf16_f32 v180, v192, v193
    v_cvt_pk_bf16_f32 v181, v194, v195
    v_pk_mul_f32 v[192:193], v[114:115], v[232:233] op_sel:[0,0] op_sel_hi:[1,0]
    v_pk_fma_f32 v[192:193], v[60:61], v[110:111], v[192:193]
    v_pk_mul_f32 v[194:195], v[116:117], v[232:233] op_sel:[0,0] op_sel_hi:[1,0]
    v_pk_fma_f32 v[194:195], v[62:63], v[112:113], v[194:195]
    s_add_u32 s70, s68, 96
    v_cvt_pk_bf16_f32 v182, v192, v193
    v_cvt_pk_bf16_f32 v183, v194, v195
    v_pk_mul_f32 v[192:193], v[122:123], v[232:233] op_sel:[0,0] op_sel_hi:[1,0]
    v_pk_fma_f32 v[192:193], v[64:65], v[118:119], v[192:193]
    v_pk_mul_f32 v[194:195], v[124:125], v[232:233] op_sel:[0,0] op_sel_hi:[1,0]
    v_pk_fma_f32 v[194:195], v[66:67], v[120:121], v[194:195]
    v_cvt_pk_bf16_f32 v184, v192, v193
    v_cvt_pk_bf16_f32 v185, v194, v195
    buffer_load_dwordx4 v[208:211], v142, s[40:43], s70 offen sc1
    v_pk_mul_f32 v[192:193], v[130:131], v[232:233] op_sel:[0,0] op_sel_hi:[1,0]
    v_pk_fma_f32 v[192:193], v[68:69], v[126:127], v[192:193]
    v_pk_mul_f32 v[194:195], v[132:133], v[232:233] op_sel:[0,0] op_sel_hi:[1,0]
    v_pk_fma_f32 v[194:195], v[70:71], v[128:129], v[194:195]
    v_cvt_pk_bf16_f32 v186, v192, v193
    v_cvt_pk_bf16_f32 v187, v194, v195
    s_cmp_lg_u32 s4, 0
    s_cbranch_scc1 L_nomask_5
    s_nop 1
    v_mov_b32 v32, 0xf149f2ca
    v_mov_b32 v33, 0xf149f2ca
    v_mov_b32 v34, 0xf149f2ca
    v_mov_b32 v35, 0xf149f2ca
    s_nop 2
L_nomask_5:
    v_cndmask_b32 v16, v16, v17, s[54:55]
    v_cndmask_b32 v32, v32, v33, s[54:55]
    s_add_u32 s70, s68, 64
    v_cndmask_b32 v48, v32, v16, s[56:57]
    v_cndmask_b32 v18, v18, v19, s[54:55]
    v_cndmask_b32 v34, v34, v35, s[54:55]
    v_cndmask_b32 v49, v34, v18, s[58:59]
    v_cvt_pk_bf16_f32 v49, v48, v49
    v_lshlrev_b32 v48, 16, v49
    v_and_b32 v49, 0xffff0000, v49
    v_max_f32 v56, v48, v49
    buffer_load_dwordx2 v[214:215], v142, s[40:43], s70 offen sc1
    v_cndmask_b32 v20, v20, v21, s[54:55]
    v_cndmask_b32 v36, v36, v37, s[54:55]
    v_cndmask_b32 v50, v36, v20, s[56:57]
    v_cndmask_b32 v22, v22, v23, s[54:55]
    v_cndmask_b32 v38, v38, v39, s[54:55]
    v_cndmask_b32 v51, v38, v22, s[58:59]
    v_cvt_pk_bf16_f32 v51, v50, v51
    v_lshlrev_b32 v50, 16, v51
    v_and_b32 v51, 0xffff0000, v51
    v_max_f32 v57, v50, v51
    v_cndmask_b32 v24, v24, v25, s[54:55]
    v_cndmask_b32 v40, v40, v41, s[54:55]
    v_cndmask_b32 v52, v40, v24, s[56:57]
    v_cndmask_b32 v26, v26, v27, s[54:55]
    v_cndmask_b32 v42, v42, v43, s[54:55]
    v_cndmask_b32 v53, v42, v26, s[58:59]
    v_cvt_pk_bf16_f32 v53, v52, v53
    v_lshlrev_b32 v52, 16, v53
    v_and_b32 v53, 0xffff0000, v53
    v_max_f32 v58, v52, v53
    v_cndmask_b32 v28, v28, v29, s[54:55]
    v_cndmask_b32 v44, v44, v45, s[54:55]
    v_cndmask_b32 v54, v44, v28, s[56:57]
    v_cndmask_b32 v30, v30, v31, s[54:55]
    v_cndmask_b32 v46, v46, v47, s[54:55]
    v_cndmask_b32 v55, v46, v30, s[58:59]
    v_cvt_pk_bf16_f32 v55, v54, v55
    v_lshlrev_b32 v54, 16, v55
    v_and_b32 v55, 0xffff0000, v55
    v_max_f32 v59, v54, v55
    v_mov_b32 v60, v56
    v_mov_b32 v61, v57
    v_mov_b32 v62, v58
    v_mov_b32 v63, v59
    v_permlane16_swap_b32 v56, v60
    v_permlane16_swap_b32 v57, v61
    v_permlane16_swap_b32 v58, v62
    v_permlane16_swap_b32 v59, v63
    v_max_f32 v56, v56, v60
    v_max_f32 v57, v57, v61
    v_max_f32 v58, v58, v62
    v_max_f32 v59, v59, v63
    v_mov_b32 v60, v56
    v_mov_b32 v61, v57
    v_mov_b32 v62, v58
    v_mov_b32 v63, v59
    v_permlane32_swap_b32 v56, v60
    v_permlane32_swap_b32 v57, v61
    v_permlane32_swap_b32 v58, v62
    v_permlane32_swap_b32 v59, v63
    v_max_f32 v56, v56, v60
    v_max_f32 v57, v57, v61
    v_max_f32 v58, v58, v62
    v_max_f32 v59, v59, v63
    s_mov_b32 s61, 0x3eb8aa3b
    v_sub_f32 v48, v48, v56
    v_sub_f32 v49, v49, v56
    v_sub_f32 v50, v50, v57
    v_sub_f32 v51, v51, v57
    v_sub_f32 v52, v52, v58
    v_sub_f32 v53, v53, v58
    v_sub_f32 v54, v54, v59
    v_sub_f32 v55, v55, v59
    v_mul_f32 v48, s61, v48
    v_mul_f32 v49, s61, v49
    v_mul_f32 v50, s61, v50
    v_mul_f32 v51, s61, v51
    v_mul_f32 v52, s61, v52
    v_mul_f32 v53, s61, v53
    v_mul_f32 v54, s61, v54
    v_mul_f32 v55, s61, v55
    v_exp_f32 v48, v48
    v_exp_f32 v49, v49
    v_exp_f32 v50, v50
    v_exp_f32 v51, v51
    v_exp_f32 v52, v52
    v_exp_f32 v53, v53
    v_exp_f32 v54, v54
    v_exp_f32 v55, v55
    v_add_f32 v56, v48, v49
    v_add_f32 v57, v50, v51
    v_add_f32 v58, v52, v53
    v_add_f32 v59, v54, v55
    v_mov_b32 v60, v56
    v_mov_b32 v61, v57
    v_mov_b32 v62, v58
    v_mov_b32 v63, v59
    v_permlane16_swap_b32 v56, v60
    v_permlane16_swap_b32 v57, v61
    v_permlane16_swap_b32 v58, v62
    v_permlane16_swap_b32 v59, v63
    v_add_f32 v56, v56, v60
    v_add_f32 v57, v57, v61
    v_add_f32 v58, v58, v62
    v_add_f32 v59, v59, v63
    v_mov_b32 v60, v56
    v_mov_b32 v61, v57
    v_mov_b32 v62, v58
    v_mov_b32 v63, v59
    v_permlane32_swap_b32 v56, v60
    v_permlane32_swap_b32 v57, v61
    v_permlane32_swap_b32 v58, v62
    v_permlane32_swap_b32 v59, v63
    v_add_f32 v56, v56, v60
    v_add_f32 v57, v57, v61
    v_add_f32 v58, v58, v62
    v_add_f32 v59, v59, v63
    v_rcp_f32 v56, v56
    v_rcp_f32 v57, v57
    v_rcp_f32 v58, v58
    v_rcp_f32 v59, v59
    v_cndmask_b32 v60, v56, 0, s[54:55]
    v_cndmask_b32 v61, 0, v56, s[54:55]
    v_mul_f32 v62, v48, v60
    v_mul_f32 v63, v48, v61
    v_cvt_pk_bf16_f32 v62, v62, v63
    v_cndmask_b32 v16, 0, v62, s[56:57]
    v_cndmask_b32 v24, v62, 0, s[56:57]
    v_mul_f32 v62, v49, v60
    v_mul_f32 v63, v49, v61
    v_cvt_pk_bf16_f32 v62, v62, v63
    v_cndmask_b32 v17, 0, v62, s[58:59]
    v_cndmask_b32 v25, v62, 0, s[58:59]
    v_cndmask_b32 v60, v57, 0, s[54:55]
    v_cndmask_b32 v61, 0, v57, s[54:55]
    v_mul_f32 v62, v50, v60
    v_mul_f32 v63, v50, v61
    v_cvt_pk_bf16_f32 v62, v62, v63
    v_cndmask_b32 v18, 0, v62, s[56:57]
    v_cndmask_b32 v26, v62, 0, s[56:57]
    v_mul_f32 v62, v51, v60
    v_mul_f32 v63, v51, v61
    v_cvt_pk_bf16_f32 v62, v62, v63
    v_cndmask_b32 v19, 0, v62, s[58:59]
    v_cndmask_b32 v27, v62, 0, s[58:59]
    v_cndmask_b32 v60, v58, 0, s[54:55]
    v_cndmask_b32 v61, 0, v58, s[54:55]
    v_mul_f32 v62, v52, v60
    v_mul_f32 v63, v52, v61
    v_cvt_pk_bf16_f32 v62, v62, v63
    v_cndmask_b32 v20, 0, v62, s[56:57]
    v_cndmask_b32 v28, v62, 0, s[56:57]
    v_mul_f32 v62, v53, v60
    v_mul_f32 v63, v53, v61
    v_cvt_pk_bf16_f32 v62, v62, v63
    v_cndmask_b32 v21, 0, v62, s[58:59]
    v_cndmask_b32 v29, v62, 0, s[58:59]
    v_cndmask_b32 v60, v59, 0, s[54:55]
    v_cndmask_b32 v61, 0, v59, s[54:55]
    v_mul_f32 v62, v54, v60
    v_mul_f32 v63, v54, v61
    v_cvt_pk_bf16_f32 v62, v62, v63
    v_cndmask_b32 v22, 0, v62, s[56:57]
    v_cndmask_b32 v30, v62, 0, s[56:57]
    v_mul_f32 v62, v55, v60
    v_mul_f32 v63, v55, v61
    v_cvt_pk_bf16_f32 v62, v62, v63
    v_cndmask_b32 v23, 0, v62, s[58:59]
    v_cndmask_b32 v31, v62, 0, s[58:59]
    v_mfma_f32_16x16x16_bf16 v[32:35], v[180:181], v[16:17], 0
    v_mfma_f32_16x16x16_bf16 v[36:39], v[182:183], v[18:19], 0
    v_mfma_f32_16x16x16_bf16 v[40:43], v[184:185], v[20:21], 0
    v_mfma_f32_16x16x16_bf16 v[44:47], v[186:187], v[22:23], 0
    v_mfma_f32_16x16x16_bf16 v[32:35], v[178:179], v[24:25], v[32:35]
    v_mfma_f32_16x16x16_bf16 v[36:39], v[180:181], v[26:27], v[36:39]
    v_mfma_f32_16x16x16_bf16 v[40:43], v[182:183], v[28:29], v[40:43]
    v_mfma_f32_16x16x16_bf16 v[44:47], v[184:185], v[30:31], v[44:47]
    s_waitcnt vmcnt(1)
    v_cmp_eq_u64 vcc, s[78:79], v[208:209]
    v_cmp_eq_u32 s[72:73], s77, v210
    s_nop 0
    s_and_b32 s61, vcc_lo, s72
    s_and_b32 s62, s61, 0xff
    s_cmp_eq_u32 s62, 0xff
    s_cselect_b32 s74, 1, 0
    s_cmp_eq_u32 s4, 31
    s_cselect_b32 s62, 0xff00, 0
    s_or_b32 s61, s61, s62
    s_and_b32 s61, s61, 0xffff
    s_cmp_eq_u32 s61, 0xffff
    s_cselect_b32 s76, 1, 0
    v_cvt_pk_bf16_f32 v48, v32, v33
    v_cvt_pk_bf16_f32 v49, v34, v35
    v_cvt_pk_bf16_f32 v50, v36, v37
    v_cvt_pk_bf16_f32 v51, v38, v39
    v_cvt_pk_bf16_f32 v52, v40, v41
    v_cvt_pk_bf16_f32 v53, v42, v43
    v_cvt_pk_bf16_f32 v54, v44, v45
    v_cvt_pk_bf16_f32 v55, v46, v47
    v_lshrrev_b32 v13, 1, v3
    s_lshl_b32 s61, s3, 1
    v_add_u32 v13, s61, v13
    v_and_b32 v14, 7, v2
    v_xor_b32 v13, v13, v14
    v_lshlrev_b32 v13, 4, v13
    v_lshl_add_u32 v13, v2, 7, v13
    v_and_b32 v14, 1, v3
    v_lshl_add_u32 v13, v14, 3, v13
    v_add_u32 v13, 155648, v13
    ds_write_b64 v13, v[48:49] offset:0
    ds_write_b64 v13, v[50:51] offset:2048
    ds_write_b64 v13, v[52:53] offset:4096
    ds_write_b64 v13, v[54:55] offset:6144
    v_lshlrev_b32 v14, 4, v0
    v_add_u32 v14, 155648, v14
    v_lshrrev_b32 v15, 3, v0
    v_xor_b32 v13, v0, v15
    v_and_b32 v13, 7, v13
    v_lshlrev_b32 v13, 4, v13
    v_lshl_add_u32 v13, v15, 10, v13
    s_waitcnt lgkmcnt(0)
    s_barrier
    ds_read_b128 v[56:59], v14 offset:0
    ds_read_b128 v[60:63], v14 offset:4096
    s_waitcnt lgkmcnt(0)
    s_add_u32 s61, s69, 4194304
    s_add_u32 s62, s61, 32768
    s_cmp_lg_u32 s74, 0
    s_cbranch_scc1 L_sp_6
    buffer_store_dwordx4 v[56:59], v13, s[40:43], s61 offen sc1
    buffer_store_dwordx4 v[60:63], v13, s[40:43], s62 offen sc1
    s_branch L_se_7
L_sp_6:
    buffer_store_dwordx4 v[56:59], v13, s[40:43], s61 offen
    buffer_store_dwordx4 v[60:63], v13, s[40:43], s62 offen
L_se_7:
    s_waitcnt vmcnt(0)
    s_barrier
    s_cmp_lg_u32 s3, 0
    s_cbranch_scc1 L_sig_8
    s_lshl_b32 s61, s4, 3
    v_add_u32 v14, s61, v1
    v_lshlrev_b32 v14, 15, v14
    s_lshl_b32 s61, s5, 7
    s_add_u32 s61, s61, 16801792
    v_add_u32 v14, s61, v14
    v_mov_b32 v222, s78
    v_mov_b32 v223, s79
    s_mov_b32 exec_lo, 0xff
    s_mov_b32 exec_hi, 0
    s_cmp_lg_u32 s74, 0
    s_cbranch_scc1 L_sp_9
    buffer_store_dwordx2 v[222:223], v14, s[40:43], 0 offen sc1
    s_branch L_se_10
L_sp_9:
    buffer_store_dwordx2 v[222:223], v14, s[40:43], 0 offen
L_se_10:
    s_mov_b64 exec, -1
    s_nop 1
L_sig_8:
    s_waitcnt vmcnt(0)
    s_mov_b32 exec_lo, 0xffffffff
    s_mov_b32 exec_hi, 0
    v_cmp_ne_u64 vcc, s[78:79], v[214:215]
    s_mov_b64 exec, -1
    s_cbranch_vccz L_achk_11
    s_mov_b32 exec_lo, 0xffffffff
    s_mov_b32 exec_hi, 0
    s_add_u32 s61, s68, 64
    s_nop 1
L_poll_s1_12:
    buffer_load_dwordx2 v[222:223], v142, s[40:43], s61 offen sc1
    s_waitcnt vmcnt(0)
    v_cmp_ne_u64 vcc, s[78:79], v[222:223]
    s_cbranch_vccnz L_poll_s1_12
    s_mov_b64 exec, -1
    s_nop 2
L_achk_11:
    s_lshl_b32 s61, s60, 13
    s_lshl_b32 s62, s3, 11
    s_add_u32 s61, s61, s62
    s_add_u32 s61, s61, 0
    s_lshr_b32 s63, s3, 1
    s_mul_i32 s63, s63, 512
    s_add_u32 s63, s63, s62
    s_add_u32 m0, s63, 65536
    s_nop 0
    buffer_load_dwordx4 v4, s[40:43], s61 offen sc1 lds
    buffer_load_dwordx4 v4, s[40:43], s61 offen offset:1024 sc1 lds
    v_mov_b32 v160, 0
    v_mov_b32 v161, 0
    v_mov_b32 v162, 0
    v_mov_b32 v163, 0
    s_mov_b32 exec_lo, -1
    s_mov_b32 exec_hi, 0
    v_add_u32 v15, 69632, v4
    ds_write_b128 v15, v[160:163]
    ds_write_b128 v15, v[160:163] offset:4608
    s_mov_b64 exec, 3
    v_add_u32 v15, 74752, v4
    ds_write_b128 v15, v[160:163]
    ds_write_b128 v15, v[160:163] offset:8320
    s_mov_b64 exec, 1
    ds_write_b128 v15, v[160:163] offset:4160
    ds_write_b128 v15, v[160:163] offset:12480
    s_mov_b64 exec, -1
    v_lshlrev_b32 v13, 4, v0
    v_add_u32 v13, 74784, v13
    v_cmp_eq_u32 vcc, 255, v0
    s_nop 1
    v_cndmask_b32 v148, v148, 0, vcc
    ds_write_b128 v13, v[144:147] offset:0
    v_alignbit_b32 v164, v145, v144, 16
    v_alignbit_b32 v165, v146, v145, 16
    v_alignbit_b32 v166, v147, v146, 16
    v_alignbit_b32 v167, v148, v147, 16
    ds_write_b128 v13, v[164:167] offset:4160
    v_cndmask_b32 v156, v156, 0, vcc
    ds_write_b128 v13, v[152:155] offset:8320
    v_alignbit_b32 v168, v153, v152, 16
    v_alignbit_b32 v169, v154, v153, 16
    v_alignbit_b32 v170, v155, v154, 16
    v_alignbit_b32 v171, v156, v155, 16
    ds_write_b128 v13, v[168:171] offset:12480
    v_cmp_eq_u32 vcc, 0, v0
    s_nop 0
    s_and_saveexec_b64 s[72:73], vcc
    v_mov_b32 v15, 74752
    v_lshlrev_b32 v163, 16, v144
    ds_write_b128 v15, v[160:163] offset:4176
    v_mov_b32 v172, 0
    v_mov_b32 v173, 0
    v_mov_b32 v174, 0
    v_lshlrev_b32 v175, 16, v152
    ds_write_b128 v15, v[172:175] offset:12496
    s_mov_b64 exec, s[72:73]
    v_add_u32 v13, 1, v2
    v_and_b32 v13, 30, v13
    v_lshlrev_b32 v13, 1, v13
    v_lshlrev_b32 v14, 4, v3
    v_sub_u32 v13, v13, v14
    v_mov_b32 v14, 4160
    v_cndmask_b32 v14, v14, 0, s[54:55]
    v_add_u32 v13, v13, v14
    s_lshr_b32 s61, s3, 1
    s_mul_i32 s62, s61, 8320
    s_and_b32 s63, s3, 1
    s_lshl_b32 s63, s63, 8
    s_sub_u32 s62, s62, s63
    s_add_u32 s64, s62, 78128
    v_add_u32 v116, s64, v13
    s_add_u32 s64, s62, 77104
    v_add_u32 v117, s64, v13
    s_add_u32 s64, s62, 76080
    v_add_u32 v118, s64, v13
    s_add_u32 s64, s62, 75056
    v_add_u32 v119, s64, v13
    v_lshlrev_b32 v13, 5, v2
    v_lshl_add_u32 v13, v3, 4, v13
    s_mul_i32 s62, s61, 4608
    s_sub_u32 s62, s62, s63
    s_add_u32 s62, s62, 66320
    v_sub_u32 v120, s62, v13
    s_waitcnt vmcnt(0) lgkmcnt(0)
    s_barrier
    ds_read2_b32 v[16:17], v116 offset0:176 offset1:177
    ds_read2_b32 v[18:19], v116 offset0:178 offset1:179
    ds_read2_b32 v[20:21], v116 offset0:48 offset1:49
    ds_read2_b32 v[22:23], v116 offset0:50 offset1:51
    ds_read2_b32 v[24:25], v117 offset0:176 offset1:177
    ds_read2_b32 v[26:27], v117 offset0:178 offset1:179
    ds_read2_b32 v[28:29], v117 offset0:48 offset1:49
    ds_read2_b32 v[30:31], v117 offset0:50 offset1:51
    ds_read2_b32 v[32:33], v118 offset0:176 offset1:177
    ds_read2_b32 v[34:35], v118 offset0:178 offset1:179
    ds_read2_b32 v[36:37], v118 offset0:48 offset1:49
    ds_read2_b32 v[38:39], v118 offset0:50 offset1:51
    ds_read2_b32 v[40:41], v119 offset0:176 offset1:177
    ds_read2_b32 v[42:43], v119 offset0:178 offset1:179
    ds_read2_b32 v[44:45], v119 offset0:48 offset1:49
    ds_read2_b32 v[46:47], v119 offset0:50 offset1:51
    ds_read_b128 v[48:51], v120 offset:3776
    ds_read_b128 v[52:55], v120 offset:3264
    ds_read_b128 v[56:59], v120 offset:2752
    ds_read_b128 v[60:63], v120 offset:2240
    ds_read_b128 v[64:67], v120 offset:1728
    ds_read_b128 v[68:71], v120 offset:1216
    ds_read_b128 v[72:75], v120 offset:704
    ds_read_b128 v[76:79], v120 offset:192
    s_waitcnt lgkmcnt(0)
    v_mfma_f32_16x16x32_bf16 v[112:115], v[16:19], v[48:51], 0
    ds_read2_b32 v[144:145], v116 offset0:160 offset1:161
    v_mfma_f32_16x16x32_bf16 v[108:111], v[20:23], v[48:51], 0
    ds_read2_b32 v[146:147], v116 offset0:162 offset1:163
    v_mfma_f32_16x16x32_bf16 v[104:107], v[24:27], v[48:51], 0
    v_lshlrev_b32 v122, 10, v2
    ds_read2_b32 v[148:149], v116 offset0:32 offset1:33
    v_mfma_f32_16x16x32_bf16 v[100:103], v[28:31], v[48:51], 0
    ds_read2_b32 v[150:151], v116 offset0:34 offset1:35
    v_mfma_f32_16x16x32_bf16 v[96:99], v[32:35], v[48:51], 0
    ds_read2_b32 v[152:153], v117 offset0:160 offset1:161
    v_mfma_f32_16x16x32_bf16 v[92:95], v[36:39], v[48:51], 0
    v_lshl_add_u32 v122, v3, 3, v122
    ds_read2_b32 v[154:155], v117 offset0:162 offset1:163
    v_mfma_f32_16x16x32_bf16 v[88:91], v[40:43], v[48:51], 0
    ds_read2_b32 v[156:157], v117 offset0:32 offset1:33
    v_mfma_f32_16x16x32_bf16 v[84:87], v[44:47], v[48:51], 0
    s_lshl_b32 s71, s3, 5
    ds_read2_b32 v[158:159], v117 offset0:34 offset1:35
    v_mfma_f32_16x16x32_bf16 v[112:115], v[20:23], v[52:55], v[112:115]
    ds_read2_b32 v[160:161], v118 offset0:160 offset1:161
    v_mfma_f32_16x16x32_bf16 v[108:111], v[24:27], v[52:55], v[108:111]
    ds_read2_b32 v[162:163], v118 offset0:162 offset1:163
    v_mfma_f32_16x16x32_bf16 v[104:107], v[28:31], v[52:55], v[104:107]
    s_add_u32 s71, s71, s69
    ds_read2_b32 v[164:165], v118 offset0:32 offset1:33
    v_mfma_f32_16x16x32_bf16 v[100:103], v[32:35], v[52:55], v[100:103]
    ds_read2_b32 v[166:167], v118 offset0:34 offset1:35
    v_mfma_f32_16x16x32_bf16 v[96:99], v[36:39], v[52:55], v[96:99]
    buffer_load_dwordx2 v[240:241], v122, s[8:11], s71 offen
    ds_read2_b32 v[168:169], v119 offset0:160 offset1:161
    v_mfma_f32_16x16x32_bf16 v[92:95], v[40:43], v[52:55], v[92:95]
    ds_read2_b32 v[170:171], v119 offset0:162 offset1:163
    v_mfma_f32_16x16x32_bf16 v[88:91], v[44:47], v[52:55], v[88:91]
    ds_read2_b32 v[172:173], v119 offset0:32 offset1:33
    v_mfma_f32_16x16x32_bf16 v[112:115], v[24:27], v[56:59], v[112:115]
    s_add_u32 s71, s71, 16384
    ds_read2_b32 v[174:175], v119 offset0:34 offset1:35
    v_mfma_f32_16x16x32_bf16 v[108:111], v[28:31], v[56:59], v[108:111]
    ds_read_b128 v[176:179], v120 offset:3712
    v_mfma_f32_16x16x32_bf16 v[104:107], v[32:35], v[56:59], v[104:107]
    buffer_load_dwordx2 v[242:243], v122, s[8:11], s71 offen
    ds_read_b128 v[180:183], v120 offset:3200
    v_mfma_f32_16x16x32_bf16 v[100:103], v[36:39], v[56:59], v[100:103]
    ds_read_b128 v[184:187], v120 offset:2688
    v_mfma_f32_16x16x32_bf16 v[96:99], v[40:43], v[56:59], v[96:99]
    ds_read_b128 v[188:191], v120 offset:2176
    v_mfma_f32_16x16x32_bf16 v[92:95], v[44:47], v[56:59], v[92:95]
    s_add_u32 s71, s71, 16384
    ds_read_b128 v[192:195], v120 offset:1664
    v_mfma_f32_16x16x32_bf16 v[112:115], v[28:31], v[60:63], v[112:115]
    ds_read_b128 v[196:199], v120 offset:1152
    v_mfma_f32_16x16x32_bf16 v[108:111], v[32:35], v[60:63], v[108:111]
    ds_read_b128 v[200:203], v120 offset:640
    v_mfma_f32_16x16x32_bf16 v[104:107], v[36:39], v[60:63], v[104:107]
    buffer_load_dwordx2 v[244:245], v122, s[8:11], s71 offen
    ds_read_b128 v[204:207], v120 offset:128
    v_mfma_f32_16x16x32_bf16 v[100:103], v[40:43], v[60:63], v[100:103]
    ds_read_b64_tr_b16 a[192:193], v9 offset:0
    v_mfma_f32_16x16x32_bf16 v[96:99], v[44:47], v[60:63], v[96:99]
    s_add_u32 s71, s71, 16384
    ds_read_b64_tr_b16 a[194:195], v9 offset:2048
    v_mfma_f32_16x16x32_bf16 v[112:115], v[32:35], v[64:67], v[112:115]
    ds_read_b64_tr_b16 a[196:197], v9 offset:4096
    v_mfma_f32_16x16x32_bf16 v[108:111], v[36:39], v[64:67], v[108:111]
    ds_read_b64_tr_b16 a[198:199], v9 offset:6144
    v_mfma_f32_16x16x32_bf16 v[104:107], v[40:43], v[64:67], v[104:107]
    buffer_load_dwordx2 v[246:247], v122, s[8:11], s71 offen
    ds_read_b64_tr_b16 a[200:201], v9 offset:8192
    v_mfma_f32_16x16x32_bf16 v[100:103], v[44:47], v[64:67], v[100:103]
    ds_read_b64_tr_b16 a[202:203], v9 offset:10240
    v_mfma_f32_16x16x32_bf16 v[112:115], v[36:39], v[68:71], v[112:115]
    s_add_u32 s70, s68, 96
    v_mfma_f32_16x16x32_bf16 v[108:111], v[40:43], v[68:71], v[108:111]
    v_mfma_f32_16x16x32_bf16 v[104:107], v[44:47], v[68:71], v[104:107]
    v_mfma_f32_16x16x32_bf16 v[112:115], v[40:43], v[72:75], v[112:115]
    buffer_load_dwordx4 v[208:211], v142, s[40:43], s70 offen sc1
    v_mfma_f32_16x16x32_bf16 v[108:111], v[44:47], v[72:75], v[108:111]
    v_mfma_f32_16x16x32_bf16 v[112:115], v[44:47], v[76:79], v[112:115]
    s_waitcnt lgkmcnt(0)
    v_mfma_f32_16x16x32_bf16 v[112:115], v[144:147], v[176:179], v[112:115]
    ds_read2_b32 v[16:17], v116 offset0:144 offset1:145
    v_mfma_f32_16x16x32_bf16 v[108:111], v[148:151], v[176:179], v[108:111]
    ds_read2_b32 v[18:19], v116 offset0:146 offset1:147
    v_mfma_f32_16x16x32_bf16 v[104:107], v[152:155], v[176:179], v[104:107]
    ds_read2_b32 v[20:21], v116 offset0:16 offset1:17
    v_mfma_f32_16x16x32_bf16 v[100:103], v[156:159], v[176:179], v[100:103]
    ds_read2_b32 v[22:23], v116 offset0:18 offset1:19
    v_mfma_f32_16x16x32_bf16 v[96:99], v[160:163], v[176:179], v[96:99]
    ds_read2_b32 v[24:25], v117 offset0:144 offset1:145
    v_mfma_f32_16x16x32_bf16 v[92:95], v[164:167], v[176:179], v[92:95]
    ds_read2_b32 v[26:27], v117 offset0:146 offset1:147
    v_mfma_f32_16x16x32_bf16 v[88:91], v[168:171], v[176:179], v[88:91]
    ds_read2_b32 v[28:29], v117 offset0:16 offset1:17
    v_mfma_f32_16x16x32_bf16 v[84:87], v[172:175], v[176:179], v[84:87]
    ds_read2_b32 v[30:31], v117 offset0:18 offset1:19
    v_mfma_f32_16x16x32_bf16 v[112:115], v[148:151], v[180:183], v[112:115]
    ds_read2_b32 v[32:33], v118 offset0:144 offset1:145
    v_mfma_f32_16x16x32_bf16 v[108:111], v[152:155], v[180:183], v[108:111]
    ds_read2_b32 v[34:35], v118 offset0:146 offset1:147
    v_mfma_f32_16x16x32_bf16 v[104:107], v[156:159], v[180:183], v[104:107]
    ds_read2_b32 v[36:37], v118 offset0:16 offset1:17
    v_mfma_f32_16x16x32_bf16 v[100:103], v[160:163], v[180:183], v[100:103]
    ds_read2_b32 v[38:39], v118 offset0:18 offset1:19
    v_mfma_f32_16x16x32_bf16 v[96:99], v[164:167], v[180:183], v[96:99]
    ds_read2_b32 v[40:41], v119 offset0:144 offset1:145
    v_mfma_f32_16x16x32_bf16 v[92:95], v[168:171], v[180:183], v[92:95]
    ds_read2_b32 v[42:43], v119 offset0:146 offset1:147
    v_mfma_f32_16x16x32_bf16 v[88:91], v[172:175], v[180:183], v[88:91]
    ds_read2_b32 v[44:45], v119 offset0:16 offset1:17
    v_mfma_f32_16x16x32_bf16 v[112:115], v[152:155], v[184:187], v[112:115]
    ds_read2_b32 v[46:47], v119 offset0:18 offset1:19
    v_mfma_f32_16x16x32_bf16 v[108:111], v[156:159], v[184:187], v[108:111]
    ds_read_b128 v[48:51], v120 offset:3648
    v_mfma_f32_16x16x32_bf16 v[104:107], v[160:163], v[184:187], v[104:107]
    ds_read_b128 v[52:55], v120 offset:3136
    v_mfma_f32_16x16x32_bf16 v[100:103], v[164:167], v[184:187], v[100:103]
    ds_read_b128 v[56:59], v120 offset:2624
    v_mfma_f32_16x16x32_bf16 v[96:99], v[168:171], v[184:187], v[96:99]
    ds_read_b128 v[60:63], v120 offset:2112
    v_mfma_f32_16x16x32_bf16 v[92:95], v[172:175], v[184:187], v[92:95]
    ds_read_b128 v[64:67], v120 offset:1600
    v_mfma_f32_16x16x32_bf16 v[112:115], v[156:159], v[188:191], v[112:115]
    ds_read_b128 v[68:71], v120 offset:1088
    v_mfma_f32_16x16x32_bf16 v[108:111], v[160:163], v[188:191], v[108:111]
    ds_read_b128 v[72:75], v120 offset:576
    v_mfma_f32_16x16x32_bf16 v[104:107], v[164:167], v[188:191], v[104:107]
    ds_read_b128 v[76:79], v120 offset:64
    v_mfma_f32_16x16x32_bf16 v[100:103], v[168:171], v[188:191], v[100:103]
    ds_read_b64_tr_b16 a[204:205], v9 offset:12288
    v_mfma_f32_16x16x32_bf16 v[96:99], v[172:175], v[188:191], v[96:99]
    ds_read_b64_tr_b16 a[206:207], v9 offset:14336
    v_mfma_f32_16x16x32_bf16 v[112:115], v[160:163], v[192:195], v[112:115]
    ds_read_b64_tr_b16 a[208:209], v9 offset:16384
    v_mfma_f32_16x16x32_bf16 v[108:111], v[164:167], v[192:195], v[108:111]
    ds_read_b64_tr_b16 a[210:211], v9 offset:18432
    v_mfma_f32_16x16x32_bf16 v[104:107], v[168:171], v[192:195], v[104:107]
    ds_read_b64_tr_b16 a[212:213], v9 offset:20480
    v_mfma_f32_16x16x32_bf16 v[100:103], v[172:175], v[192:195], v[100:103]
    ds_read_b64_tr_b16 a[214:215], v9 offset:22528
    v_mfma_f32_16x16x32_bf16 v[112:115], v[164:167], v[196:199], v[112:115]
    v_mfma_f32_16x16x32_bf16 v[108:111], v[168:171], v[196:199], v[108:111]
    v_mfma_f32_16x16x32_bf16 v[104:107], v[172:175], v[196:199], v[104:107]
    v_mfma_f32_16x16x32_bf16 v[112:115], v[168:171], v[200:203], v[112:115]
    v_mfma_f32_16x16x32_bf16 v[108:111], v[172:175], v[200:203], v[108:111]
    v_mfma_f32_16x16x32_bf16 v[112:115], v[172:175], v[204:207], v[112:115]
    s_waitcnt lgkmcnt(0)
    v_mfma_f32_16x16x32_bf16 v[112:115], v[16:19], v[48:51], v[112:115]
    ds_read2_b32 v[144:145], v116 offset0:128 offset1:129
    v_mfma_f32_16x16x32_bf16 v[108:111], v[20:23], v[48:51], v[108:111]
    ds_read2_b32 v[146:147], v116 offset0:130 offset1:131
    v_mfma_f32_16x16x32_bf16 v[104:107], v[24:27], v[48:51], v[104:107]
    ds_read2_b32 v[148:149], v116 offset0:0 offset1:1
    v_mfma_f32_16x16x32_bf16 v[100:103], v[28:31], v[48:51], v[100:103]
    ds_read2_b32 v[150:151], v116 offset0:2 offset1:3
    v_mfma_f32_16x16x32_bf16 v[96:99], v[32:35], v[48:51], v[96:99]
    ds_read2_b32 v[152:153], v117 offset0:128 offset1:129
    v_mfma_f32_16x16x32_bf16 v[92:95], v[36:39], v[48:51], v[92:95]
    s_add_u32 s70, s68, 24576
    ds_read2_b32 v[154:155], v117 offset0:130 offset1:131
    v_mfma_f32_16x16x32_bf16 v[88:91], v[40:43], v[48:51], v[88:91]
    ds_read2_b32 v[156:157], v117 offset0:0 offset1:1
    v_mfma_f32_16x16x32_bf16 v[84:87], v[44:47], v[48:51], v[84:87]
    ds_read2_b32 v[158:159], v117 offset0:2 offset1:3
    v_mfma_f32_16x16x32_bf16 v[112:115], v[20:23], v[52:55], v[112:115]
    ds_read2_b32 v[160:161], v118 offset0:128 offset1:129
    v_mfma_f32_16x16x32_bf16 v[108:111], v[24:27], v[52:55], v[108:111]
    ds_read2_b32 v[162:163], v118 offset0:130 offset1:131
    v_mfma_f32_16x16x32_bf16 v[104:107], v[28:31], v[52:55], v[104:107]
    buffer_load_dwordx2 v[214:215], v142, s[40:43], s70 offen sc1
    ds_read2_b32 v[164:165], v118 offset0:0 offset1:1
    v_mfma_f32_16x16x32_bf16 v[100:103], v[32:35], v[52:55], v[100:103]
    ds_read2_b32 v[166:167], v118 offset0:2 offset1:3
    v_mfma_f32_16x16x32_bf16 v[96:99], v[36:39], v[52:55], v[96:99]
    ds_read2_b32 v[168:169], v119 offset0:128 offset1:129
    v_mfma_f32_16x16x32_bf16 v[92:95], v[40:43], v[52:55], v[92:95]
    ds_read2_b32 v[170:171], v119 offset0:130 offset1:131
    v_mfma_f32_16x16x32_bf16 v[88:91], v[44:47], v[52:55], v[88:91]
    ds_read2_b32 v[172:173], v119 offset0:0 offset1:1
    v_mfma_f32_16x16x32_bf16 v[112:115], v[24:27], v[56:59], v[112:115]
    ds_read2_b32 v[174:175], v119 offset0:2 offset1:3
    v_mfma_f32_16x16x32_bf16 v[108:111], v[28:31], v[56:59], v[108:111]
    ds_read_b128 v[176:179], v120 offset:3584
    v_mfma_f32_16x16x32_bf16 v[104:107], v[32:35], v[56:59], v[104:107]
    ds_read_b128 v[180:183], v120 offset:3072
    v_mfma_f32_16x16x32_bf16 v[100:103], v[36:39], v[56:59], v[100:103]
    ds_read_b128 v[184:187], v120 offset:2560
    v_mfma_f32_16x16x32_bf16 v[96:99], v[40:43], v[56:59], v[96:99]
    ds_read_b128 v[188:191], v120 offset:2048
    v_mfma_f32_16x16x32_bf16 v[92:95], v[44:47], v[56:59], v[92:95]
    ds_read_b128 v[192:195], v120 offset:1536
    v_mfma_f32_16x16x32_bf16 v[112:115], v[28:31], v[60:63], v[112:115]
    ds_read_b128 v[196:199], v120 offset:1024
    v_mfma_f32_16x16x32_bf16 v[108:111], v[32:35], v[60:63], v[108:111]
    ds_read_b128 v[200:203], v120 offset:512
    v_mfma_f32_16x16x32_bf16 v[104:107], v[36:39], v[60:63], v[104:107]
    ds_read_b128 v[204:207], v120 offset:0
    v_mfma_f32_16x16x32_bf16 v[100:103], v[40:43], v[60:63], v[100:103]
    ds_read_b64_tr_b16 a[216:217], v9 offset:24576
    v_mfma_f32_16x16x32_bf16 v[96:99], v[44:47], v[60:63], v[96:99]
    ds_read_b64_tr_b16 a[218:219], v9 offset:26624
    v_mfma_f32_16x16x32_bf16 v[112:115], v[32:35], v[64:67], v[112:115]
    ds_read_b64_tr_b16 a[220:221], v9 offset:28672
    v_mfma_f32_16x16x32_bf16 v[108:111], v[36:39], v[64:67], v[108:111]
    ds_read_b64_tr_b16 a[222:223], v9 offset:30720
    v_mfma_f32_16x16x32_bf16 v[104:107], v[40:43], v[64:67], v[104:107]
    ds_read_b64_tr_b16 a[224:225], v9 offset:32768
    v_mfma_f32_16x16x32_bf16 v[100:103], v[44:47], v[64:67], v[100:103]
    ds_read_b64_tr_b16 a[226:227], v9 offset:34816
    v_mfma_f32_16x16x32_bf16 v[112:115], v[36:39], v[68:71], v[112:115]
    v_mfma_f32_16x16x32_bf16 v[108:111], v[40:43], v[68:71], v[108:111]
    v_mfma_f32_16x16x32_bf16 v[104:107], v[44:47], v[68:71], v[104:107]
    v_mfma_f32_16x16x32_bf16 v[112:115], v[40:43], v[72:75], v[112:115]
    v_mfma_f32_16x16x32_bf16 v[108:111], v[44:47], v[72:75], v[108:111]
    v_mfma_f32_16x16x32_bf16 v[112:115], v[44:47], v[76:79], v[112:115]
    s_waitcnt lgkmcnt(0)
    s_waitcnt vmcnt(1)
    v_cmp_eq_u64 vcc, s[78:79], v[208:209]
    v_cmp_eq_u32 s[72:73], s77, v210
    s_nop 0
    s_and_b32 s61, vcc_lo, s72
    s_and_b32 s62, s61, 0xff
    s_cmp_eq_u32 s62, 0xff
    s_cselect_b32 s74, 1, 0
    s_cmp_eq_u32 s4, 31
    s_cselect_b32 s62, 0xff00, 0
    s_or_b32 s61, s61, s62
    s_and_b32 s61, s61, 0xffff
    s_cmp_eq_u32 s61, 0xffff
    s_cselect_b32 s76, 1, 0
    s_waitcnt vmcnt(0)
    s_mov_b32 exec_lo, 0xff
    s_mov_b32 exec_hi, 0
    v_cmp_ne_u64 vcc, s[78:79], v[214:215]
    s_mov_b64 exec, -1
    s_cbranch_vccz L_achk_13
    s_mov_b32 exec_lo, 0xff
    s_mov_b32 exec_hi, 0
    s_add_u32 s61, s68, 24576
    s_nop 1
L_poll_o1_14:
    buffer_load_dwordx2 v[222:223], v142, s[40:43], s61 offen sc1
    s_waitcnt vmcnt(0)
    v_cmp_ne_u64 vcc, s[78:79], v[222:223]
    s_cbranch_vccnz L_poll_o1_14
    s_mov_b64 exec, -1
    s_nop 2
L_achk_13:
    v_mfma_f32_16x16x32_bf16 v[112:115], v[144:147], v[176:179], v[112:115]
    s_lshl_b32 s80, s6, 6
    ds_read_b64_tr_b16 a[228:229], v9 offset:36864
    v_mfma_f32_16x16x32_bf16 v[108:111], v[148:151], v[176:179], v[108:111]
    v_add_u32 v212, s66, v143
    v_xor_b32 v213, 64, v212
    ds_read_b64_tr_b16 a[230:231], v9 offset:38912
    v_mfma_f32_16x16x32_bf16 v[104:107], v[152:155], v[176:179], v[104:107]
    v_add_u32 v213, 8192, v213
    s_lshl_b32 s70, s3, 11
    ds_read_b64_tr_b16 a[232:233], v9 offset:40960
    v_mfma_f32_16x16x32_bf16 v[100:103], v[156:159], v[176:179], v[100:103]
    s_add_u32 s71, s80, 4194304
    ds_read_b64_tr_b16 a[234:235], v9 offset:43008
    v_mfma_f32_16x16x32_bf16 v[96:99], v[160:163], v[176:179], v[96:99]
    s_add_u32 m0, s70, 98304
    s_nop 0
    buffer_load_dwordx4 v212, s[40:43], s71 offen sc1 lds
    ds_read_b64_tr_b16 a[236:237], v9 offset:45056
    v_mfma_f32_16x16x32_bf16 v[92:95], v[164:167], v[176:179], v[92:95]
    s_add_u32 m0, s70, 99328
    s_nop 0
    buffer_load_dwordx4 v213, s[40:43], s71 offen sc1 lds
    ds_read_b64_tr_b16 a[238:239], v9 offset:47104
    v_mfma_f32_16x16x32_bf16 v[88:91], v[168:171], v[176:179], v[88:91]
    s_add_u32 s80, s80, 128
    s_and_b32 s80, s80, 1023
    ds_read_b64_tr_b16 a[240:241], v9 offset:49152
    v_mfma_f32_16x16x32_bf16 v[84:87], v[172:175], v[176:179], v[84:87]
    s_add_u32 s71, s80, 4194304
    ds_read_b64_tr_b16 a[242:243], v9 offset:51200
    v_mfma_f32_16x16x32_bf16 v[112:115], v[148:151], v[180:183], v[112:115]
    s_add_u32 m0, s70, 106496
    s_nop 0
    buffer_load_dwordx4 v212, s[40:43], s71 offen sc1 lds
    ds_read_b64_tr_b16 a[244:245], v9 offset:53248
    v_mfma_f32_16x16x32_bf16 v[108:111], v[152:155], v[180:183], v[108:111]
    s_add_u32 m0, s70, 107520
    s_nop 0
    buffer_load_dwordx4 v213, s[40:43], s71 offen sc1 lds
    ds_read_b64_tr_b16 a[246:247], v9 offset:55296
    v_mfma_f32_16x16x32_bf16 v[104:107], v[156:159], v[180:183], v[104:107]
    s_add_u32 s80, s80, 128
    ds_read_b64_tr_b16 a[248:249], v9 offset:57344
    v_mfma_f32_16x16x32_bf16 v[100:103], v[160:163], v[180:183], v[100:103]
    s_and_b32 s80, s80, 1023
    s_add_u32 s71, s80, 4194304
    ds_read_b64_tr_b16 a[250:251], v9 offset:59392
    v_mfma_f32_16x16x32_bf16 v[96:99], v[164:167], v[180:183], v[96:99]
    s_add_u32 m0, s70, 114688
    s_nop 0
    buffer_load_dwordx4 v212, s[40:43], s71 offen sc1 lds
    ds_read_b64_tr_b16 a[252:253], v9 offset:61440
    v_mfma_f32_16x16x32_bf16 v[92:95], v[168:171], v[180:183], v[92:95]
    s_add_u32 m0, s70, 115712
    s_nop 0
    buffer_load_dwordx4 v213, s[40:43], s71 offen sc1 lds
    ds_read_b64_tr_b16 a[254:255], v9 offset:63488
    v_mfma_f32_16x16x32_bf16 v[88:91], v[172:175], v[180:183], v[88:91]
    s_add_u32 s80, s80, 128
    v_mfma_f32_16x16x32_bf16 v[112:115], v[152:155], v[184:187], v[112:115]
    s_and_b32 s80, s80, 1023
    s_add_u32 s71, s80, 4194304
    v_mfma_f32_16x16x32_bf16 v[108:111], v[156:159], v[184:187], v[108:111]
    s_add_u32 m0, s70, 122880
    s_nop 0
    buffer_load_dwordx4 v212, s[40:43], s71 offen sc1 lds
    v_mfma_f32_16x16x32_bf16 v[104:107], v[160:163], v[184:187], v[104:107]
    s_add_u32 m0, s70, 123904
    s_nop 0
    buffer_load_dwordx4 v213, s[40:43], s71 offen sc1 lds
    v_mfma_f32_16x16x32_bf16 v[100:103], v[164:167], v[184:187], v[100:103]
    s_add_u32 s80, s80, 128
    v_mfma_f32_16x16x32_bf16 v[96:99], v[168:171], v[184:187], v[96:99]
    s_and_b32 s80, s80, 1023
    s_add_u32 s71, s80, 4194304
    v_mfma_f32_16x16x32_bf16 v[92:95], v[172:175], v[184:187], v[92:95]
    s_add_u32 m0, s70, 131072
    s_nop 0
    buffer_load_dwordx4 v212, s[40:43], s71 offen sc1 lds
    v_mfma_f32_16x16x32_bf16 v[112:115], v[156:159], v[188:191], v[112:115]
    s_add_u32 m0, s70, 132096
    v_mfma_f32_16x16x32_bf16 v[108:111], v[160:163], v[188:191], v[108:111]
    buffer_load_dwordx4 v213, s[40:43], s71 offen sc1 lds
    s_add_u32 s80, s80, 128
    v_mfma_f32_16x16x32_bf16 v[104:107], v[164:167], v[188:191], v[104:107]
    s_and_b32 s80, s80, 1023
    s_add_u32 s71, s80, 4194304
    v_mfma_f32_16x16x32_bf16 v[100:103], v[168:171], v[188:191], v[100:103]
    s_add_u32 m0, s70, 139264
    s_nop 0
    buffer_load_dwordx4 v212, s[40:43], s71 offen sc1 lds
    v_mfma_f32_16x16x32_bf16 v[96:99], v[172:175], v[188:191], v[96:99]
    s_add_u32 m0, s70, 140288
    v_mfma_f32_16x16x32_bf16 v[112:115], v[160:163], v[192:195], v[112:115]
    buffer_load_dwordx4 v213, s[40:43], s71 offen sc1 lds
    s_add_u32 s80, s80, 128
    v_mfma_f32_16x16x32_bf16 v[108:111], v[164:167], v[192:195], v[108:111]
    s_and_b32 s80, s80, 1023
    s_add_u32 s71, s80, 4194304
    v_mfma_f32_16x16x32_bf16 v[104:107], v[168:171], v[192:195], v[104:107]
    s_add_u32 m0, s70, 147456
    v_mfma_f32_16x16x32_bf16 v[100:103], v[172:175], v[192:195], v[100:103]
    buffer_load_dwordx4 v212, s[40:43], s71 offen sc1 lds
    s_add_u32 m0, s70, 148480
    v_mfma_f32_16x16x32_bf16 v[112:115], v[164:167], v[196:199], v[112:115]
    buffer_load_dwordx4 v213, s[40:43], s71 offen sc1 lds
    s_add_u32 s80, s80, 128
    v_mfma_f32_16x16x32_bf16 v[108:111], v[168:171], v[196:199], v[108:111]
    s_and_b32 s80, s80, 1023
    s_add_u32 s71, s80, 4194304
    v_mfma_f32_16x16x32_bf16 v[104:107], v[172:175], v[196:199], v[104:107]
    s_add_u32 m0, s70, 155648
    v_mfma_f32_16x16x32_bf16 v[112:115], v[168:171], v[200:203], v[112:115]
    buffer_load_dwordx4 v212, s[40:43], s71 offen sc1 lds
    s_add_u32 m0, s70, 156672
    v_mfma_f32_16x16x32_bf16 v[108:111], v[172:175], v[200:203], v[108:111]
    buffer_load_dwordx4 v213, s[40:43], s71 offen sc1 lds
    s_add_u32 s80, s80, 128
    v_mfma_f32_16x16x32_bf16 v[112:115], v[172:175], v[204:207], v[112:115]
    s_and_b32 s80, s80, 1023
    s_waitcnt lgkmcnt(0)
    s_barrier
    s_lshl_b32 s61, s3, 12
    s_add_u32 s61, s61, 74752
    v_add_u32 v13, s61, v4
    s_xor_b32 s62, s3, 1
    s_lshl_b32 s62, s62, 12
    s_add_u32 s62, s62, 74752
    v_add_u32 v14, s62, v4
    s_and_b32 s63, s3, 1
    s_cmp_eq_u32 s63, 0
    s_cbranch_scc1 L_y2_even
    s_nop 1
    ds_write_b128 v13, v[84:87] offset:0
    v_mov_b32 v16, v88
    v_mov_b32 v17, v89
    v_mov_b32 v18, v90
    v_mov_b32 v19, v91
    ds_write_b128 v13, v[92:95] offset:1024
    v_mov_b32 v20, v96
    v_mov_b32 v21, v97
    v_mov_b32 v22, v98
    v_mov_b32 v23, v99
    ds_write_b128 v13, v[100:103] offset:2048
    v_mov_b32 v24, v104
    v_mov_b32 v25, v105
    v_mov_b32 v26, v106
    v_mov_b32 v27, v107
    ds_write_b128 v13, v[108:111] offset:3072
    v_mov_b32 v28, v112
    v_mov_b32 v29, v113
    v_mov_b32 v30, v114
    v_mov_b32 v31, v115
    s_branch L_y2_x
L_y2_even:
    s_nop 1
    ds_write_b128 v13, v[88:91] offset:0
    v_mov_b32 v16, v84
    v_mov_b32 v17, v85
    v_mov_b32 v18, v86
    v_mov_b32 v19, v87
    ds_write_b128 v13, v[96:99] offset:1024
    v_mov_b32 v20, v92
    v_mov_b32 v21, v93
    v_mov_b32 v22, v94
    v_mov_b32 v23, v95
    ds_write_b128 v13, v[104:107] offset:2048
    v_mov_b32 v24, v100
    v_mov_b32 v25, v101
    v_mov_b32 v26, v102
    v_mov_b32 v27, v103
    ds_write_b128 v13, v[112:115] offset:3072
    v_mov_b32 v28, v108
    v_mov_b32 v29, v109
    v_mov_b32 v30, v110
    v_mov_b32 v31, v111
L_y2_x:
    v_lshlrev_b32 v13, 5, v2
    v_lshl_add_u32 v13, v3, 3, v13
    s_lshr_b32 s61, s3, 1
    s_mul_i32 s62, s61, 4608
    s_lshl_b32 s64, s63, 9
    s_sub_u32 s62, s62, s64
    s_add_u32 s62, s62, 66552
    v_sub_u32 v15, s62, v13
    ds_read_b64 v[64:65], v15 offset:3072
    ds_read_b64 v[66:67], v15 offset:2048
    ds_read_b64 v[68:69], v15 offset:1024
    ds_read_b64 v[70:71], v15 offset:0
    s_lshl_b32 s62, s52, 16
    s_and_b32 s64, s52, 0xffff0000
    s_cmp_eq_u32 s61, 0
    s_cselect_b32 s62, s62, s64
    s_lshl_b32 s64, s60, 1
    s_add_u32 s64, s64, s61
    s_lshl_b32 s64, s64, 12
    s_lshl_b32 s75, s63, 9
    s_add_u32 s64, s64, s75
    s_add_u32 s64, s64, 0
    s_waitcnt lgkmcnt(0)
    s_barrier
    ds_read_b128 v[48:51], v14 offset:0
    ds_read_b128 v[52:55], v14 offset:1024
    ds_read_b128 v[56:59], v14 offset:2048
    ds_read_b128 v[60:63], v14 offset:3072
    v_and_b32 v144, 0xffff0000, v65
    v_lshlrev_b32 v145, 16, v65
    v_and_b32 v146, 0xffff0000, v64
    v_lshlrev_b32 v147, 16, v64
    v_mul_f32 v144, s62, v144
    v_mul_f32 v145, s62, v145
    v_mul_f32 v146, s62, v146
    v_mul_f32 v147, s62, v147
    v_cvt_pk_bf16_f32 v144, v144, v145
    v_cvt_pk_bf16_f32 v146, v146, v147
    v_and_b32 v145, 0xffff0000, v144
    v_lshlrev_b32 v144, 16, v144
    v_and_b32 v147, 0xffff0000, v146
    v_lshlrev_b32 v146, 16, v146
    v_and_b32 v148, 0xffff0000, v67
    v_lshlrev_b32 v149, 16, v67
    v_and_b32 v150, 0xffff0000, v66
    v_lshlrev_b32 v151, 16, v66
    v_mul_f32 v148, s62, v148
    v_mul_f32 v149, s62, v149
    v_mul_f32 v150, s62, v150
    v_mul_f32 v151, s62, v151
    v_cvt_pk_bf16_f32 v148, v148, v149
    v_cvt_pk_bf16_f32 v150, v150, v151
    v_and_b32 v149, 0xffff0000, v148
    v_lshlrev_b32 v148, 16, v148
    v_and_b32 v151, 0xffff0000, v150
    v_lshlrev_b32 v150, 16, v150
    v_and_b32 v152, 0xffff0000, v69
    v_lshlrev_b32 v153, 16, v69
    v_and_b32 v154, 0xffff0000, v68
    v_lshlrev_b32 v155, 16, v68
    v_mul_f32 v152, s62, v152
    v_mul_f32 v153, s62, v153
    v_mul_f32 v154, s62, v154
    v_mul_f32 v155, s62, v155
    v_cvt_pk_bf16_f32 v152, v152, v153
    v_cvt_pk_bf16_f32 v154, v154, v155
    v_and_b32 v153, 0xffff0000, v152
    v_lshlrev_b32 v152, 16, v152
    v_and_b32 v155, 0xffff0000, v154
    v_lshlrev_b32 v154, 16, v154
    v_and_b32 v156, 0xffff0000, v71
    v_lshlrev_b32 v157, 16, v71
    v_and_b32 v158, 0xffff0000, v70
    v_lshlrev_b32 v159, 16, v70
    v_mul_f32 v156, s62, v156
    v_mul_f32 v157, s62, v157
    v_mul_f32 v158, s62, v158
    v_mul_f32 v159, s62, v159
    v_cvt_pk_bf16_f32 v156, v156, v157
    v_cvt_pk_bf16_f32 v158, v158, v159
    v_and_b32 v157, 0xffff0000, v156
    v_lshlrev_b32 v156, 16, v156
    v_and_b32 v159, 0xffff0000, v158
    v_lshlrev_b32 v158, 16, v158
    s_waitcnt lgkmcnt(0)
    v_pk_add_f32 v[16:17], v[16:17], v[48:49]
    v_pk_add_f32 v[18:19], v[18:19], v[50:51]
    v_cvt_pk_bf16_f32 v16, v16, v17
    v_cvt_pk_bf16_f32 v18, v18, v19
    v_and_b32 v17, 0xffff0000, v16
    v_lshlrev_b32 v16, 16, v16
    v_and_b32 v19, 0xffff0000, v18
    v_lshlrev_b32 v18, 16, v18
    v_pk_add_f32 v[16:17], v[16:17], v[144:145]
    v_pk_add_f32 v[18:19], v[18:19], v[146:147]
    v_cvt_pk_bf16_f32 v16, v16, v17
    v_cvt_pk_bf16_f32 v17, v18, v19
    buffer_store_dwordx2 v[16:17], v13, s[40:43], s64 offen offset:0 sc1
    v_pk_add_f32 v[20:21], v[20:21], v[52:53]
    v_pk_add_f32 v[22:23], v[22:23], v[54:55]
    v_cvt_pk_bf16_f32 v20, v20, v21
    v_cvt_pk_bf16_f32 v22, v22, v23
    v_and_b32 v21, 0xffff0000, v20
    v_lshlrev_b32 v20, 16, v20
    v_and_b32 v23, 0xffff0000, v22
    v_lshlrev_b32 v22, 16, v22
    v_pk_add_f32 v[20:21], v[20:21], v[148:149]
    v_pk_add_f32 v[22:23], v[22:23], v[150:151]
    v_cvt_pk_bf16_f32 v20, v20, v21
    v_cvt_pk_bf16_f32 v21, v22, v23
    buffer_store_dwordx2 v[20:21], v13, s[40:43], s64 offen offset:1024 sc1
    v_pk_add_f32 v[24:25], v[24:25], v[56:57]
    v_pk_add_f32 v[26:27], v[26:27], v[58:59]
    v_cvt_pk_bf16_f32 v24, v24, v25
    v_cvt_pk_bf16_f32 v26, v26, v27
    v_and_b32 v25, 0xffff0000, v24
    v_lshlrev_b32 v24, 16, v24
    v_and_b32 v27, 0xffff0000, v26
    v_lshlrev_b32 v26, 16, v26
    v_pk_add_f32 v[24:25], v[24:25], v[152:153]
    v_pk_add_f32 v[26:27], v[26:27], v[154:155]
    v_cvt_pk_bf16_f32 v24, v24, v25
    v_cvt_pk_bf16_f32 v25, v26, v27
    buffer_store_dwordx2 v[24:25], v13, s[40:43], s64 offen offset:2048 sc1
    v_pk_add_f32 v[28:29], v[28:29], v[60:61]
    v_pk_add_f32 v[30:31], v[30:31], v[62:63]
    v_cvt_pk_bf16_f32 v28, v28, v29
    v_cvt_pk_bf16_f32 v30, v30, v31
    v_and_b32 v29, 0xffff0000, v28
    v_lshlrev_b32 v28, 16, v28
    v_and_b32 v31, 0xffff0000, v30
    v_lshlrev_b32 v30, 16, v30
    v_pk_add_f32 v[28:29], v[28:29], v[156:157]
    v_pk_add_f32 v[30:31], v[30:31], v[158:159]
    v_cvt_pk_bf16_f32 v28, v28, v29
    v_cvt_pk_bf16_f32 v29, v30, v31
    buffer_store_dwordx2 v[28:29], v13, s[40:43], s64 offen offset:3072 sc1
    s_add_u32 s70, s69, s66
    s_add_u32 s70, s70, 8388608
    v_lshlrev_b32 v217, 10, v2
    buffer_load_dword v216, v217, s[40:43], s70 offen sc1
    s_lshl_b32 s70, s3, 10
    s_add_u32 s70, s70, s68
    s_add_u32 s70, s70, 12288
    v_and_b32 v217, 7, v1
    v_lshlrev_b32 v217, 7, v217
    buffer_load_dword v216, v217, s[40:43], s70 offen sc1
    s_add_u32 s70, s68, 20480
    buffer_load_dword v216, v217, s[40:43], s70 offen sc1
    v_add_u32 v120, 98304, v141
    v_xor_b32 v121, 64, v120
    s_waitcnt vmcnt(19)
    s_barrier
    ds_read_b128 v[32:35], v120 offset:0
    ds_read_b128 v[36:39], v120 offset:2048
    ds_read_b128 v[40:43], v120 offset:4096
    ds_read_b128 v[44:47], v120 offset:6144
    ds_read_b128 v[48:51], v121 offset:0
    ds_read_b128 v[52:55], v121 offset:2048
    ds_read_b128 v[56:59], v121 offset:4096
    ds_read_b128 v[60:63], v121 offset:6144
    s_waitcnt lgkmcnt(4)
    v_mfma_f32_16x16x32_bf16 v[16:19], a[192:195], v[32:35], 0
    ds_read_b128 v[144:147], v120 offset:8192
    v_mfma_f32_16x16x32_bf16 v[20:23], a[192:195], v[36:39], 0
    ds_read_b128 v[148:151], v120 offset:10240
    v_mfma_f32_16x16x32_bf16 v[24:27], a[192:195], v[40:43], 0
    ds_read_b128 v[152:155], v120 offset:12288
    v_mfma_f32_16x16x32_bf16 v[28:31], a[192:195], v[44:47], 0
    ds_read_b128 v[156:159], v120 offset:14336
    s_waitcnt lgkmcnt(4)
    v_mfma_f32_16x16x32_bf16 v[16:19], a[196:199], v[48:51], v[16:19]
    ds_read_b128 v[32:35], v121 offset:8192
    v_mfma_f32_16x16x32_bf16 v[20:23], a[196:199], v[52:55], v[20:23]
    ds_read_b128 v[36:39], v121 offset:10240
    v_mfma_f32_16x16x32_bf16 v[24:27], a[196:199], v[56:59], v[24:27]
    ds_read_b128 v[40:43], v121 offset:12288
    v_mfma_f32_16x16x32_bf16 v[28:31], a[196:199], v[60:63], v[28:31]
    ds_read_b128 v[44:47], v121 offset:14336
    s_waitcnt vmcnt(15)
    s_barrier
    s_waitcnt lgkmcnt(4)
    v_mfma_f32_16x16x32_bf16 v[16:19], a[200:203], v[144:147], v[16:19]
    ds_read_b128 v[48:51], v120 offset:16384
    v_mfma_f32_16x16x32_bf16 v[20:23], a[200:203], v[148:151], v[20:23]
    ds_read_b128 v[52:55], v120 offset:18432
    v_mfma_f32_16x16x32_bf16 v[24:27], a[200:203], v[152:155], v[24:27]
    ds_read_b128 v[56:59], v120 offset:20480
    v_mfma_f32_16x16x32_bf16 v[28:31], a[200:203], v[156:159], v[28:31]
    ds_read_b128 v[60:63], v120 offset:22528
    s_waitcnt lgkmcnt(4)
    v_mfma_f32_16x16x32_bf16 v[16:19], a[204:207], v[32:35], v[16:19]
    ds_read_b128 v[144:147], v121 offset:16384
    v_mfma_f32_16x16x32_bf16 v[20:23], a[204:207], v[36:39], v[20:23]
    ds_read_b128 v[148:151], v121 offset:18432
    v_mfma_f32_16x16x32_bf16 v[24:27], a[204:207], v[40:43], v[24:27]
    ds_read_b128 v[152:155], v121 offset:20480
    v_mfma_f32_16x16x32_bf16 v[28:31], a[204:207], v[44:47], v[28:31]
    ds_read_b128 v[156:159], v121 offset:22528
    s_waitcnt lgkmcnt(4)
    v_mfma_f32_16x16x32_bf16 v[16:19], a[208:211], v[48:51], v[16:19]
    ds_read_b128 v[32:35], v120 offset:24576
    v_mfma_f32_16x16x32_bf16 v[20:23], a[208:211], v[52:55], v[20:23]
    ds_read_b128 v[36:39], v120 offset:26624
    v_mfma_f32_16x16x32_bf16 v[24:27], a[208:211], v[56:59], v[24:27]
    ds_read_b128 v[40:43], v120 offset:28672
    v_mfma_f32_16x16x32_bf16 v[28:31], a[208:211], v[60:63], v[28:31]
    ds_read_b128 v[44:47], v120 offset:30720
    s_waitcnt lgkmcnt(4)
    v_mfma_f32_16x16x32_bf16 v[16:19], a[212:215], v[144:147], v[16:19]
    ds_read_b128 v[48:51], v121 offset:24576
    v_mfma_f32_16x16x32_bf16 v[20:23], a[212:215], v[148:151], v[20:23]
    ds_read_b128 v[52:55], v121 offset:26624
    v_mfma_f32_16x16x32_bf16 v[24:27], a[212:215], v[152:155], v[24:27]
    ds_read_b128 v[56:59], v121 offset:28672
    v_mfma_f32_16x16x32_bf16 v[28:31], a[212:215], v[156:159], v[28:31]
    ds_read_b128 v[60:63], v121 offset:30720
    s_waitcnt vmcnt(11)
    s_barrier
    s_waitcnt lgkmcnt(4)
    v_mfma_f32_16x16x32_bf16 v[16:19], a[216:219], v[32:35], v[16:19]
    ds_read_b128 v[144:147], v120 offset:32768
    v_mfma_f32_16x16x32_bf16 v[20:23], a[216:219], v[36:39], v[20:23]
    ds_read_b128 v[148:151], v120 offset:34816
    v_mfma_f32_16x16x32_bf16 v[24:27], a[216:219], v[40:43], v[24:27]
    ds_read_b128 v[152:155], v120 offset:36864
    v_mfma_f32_16x16x32_bf16 v[28:31], a[216:219], v[44:47], v[28:31]
    ds_read_b128 v[156:159], v120 offset:38912
    s_waitcnt lgkmcnt(4)
    v_mfma_f32_16x16x32_bf16 v[16:19], a[220:223], v[48:51], v[16:19]
    ds_read_b128 v[32:35], v121 offset:32768
    v_mfma_f32_16x16x32_bf16 v[20:23], a[220:223], v[52:55], v[20:23]
    ds_read_b128 v[36:39], v121 offset:34816
    v_mfma_f32_16x16x32_bf16 v[24:27], a[220:223], v[56:59], v[24:27]
    ds_read_b128 v[40:43], v121 offset:36864
    v_mfma_f32_16x16x32_bf16 v[28:31], a[220:223], v[60:63], v[28:31]
    ds_read_b128 v[44:47], v121 offset:38912
    s_waitcnt lgkmcnt(4)
    v_mfma_f32_16x16x32_bf16 v[16:19], a[224:227], v[144:147], v[16:19]
    ds_read_b128 v[48:51], v120 offset:40960
    v_mfma_f32_16x16x32_bf16 v[20:23], a[224:227], v[148:151], v[20:23]
    ds_read_b128 v[52:55], v120 offset:43008
    v_mfma_f32_16x16x32_bf16 v[24:27], a[224:227], v[152:155], v[24:27]
    ds_read_b128 v[56:59], v120 offset:45056
    v_mfma_f32_16x16x32_bf16 v[28:31], a[224:227], v[156:159], v[28:31]
    ds_read_b128 v[60:63], v120 offset:47104
    s_waitcnt lgkmcnt(4)
    v_mfma_f32_16x16x32_bf16 v[16:19], a[228:231], v[32:35], v[16:19]
    ds_read_b128 v[144:147], v121 offset:40960
    v_mfma_f32_16x16x32_bf16 v[20:23], a[228:231], v[36:39], v[20:23]
    ds_read_b128 v[148:151], v121 offset:43008
    v_mfma_f32_16x16x32_bf16 v[24:27], a[228:231], v[40:43], v[24:27]
    ds_read_b128 v[152:155], v121 offset:45056
    v_mfma_f32_16x16x32_bf16 v[28:31], a[228:231], v[44:47], v[28:31]
    ds_read_b128 v[156:159], v121 offset:47104
    s_waitcnt vmcnt(7)
    s_waitcnt vmcnt(3)
    s_barrier
    s_cmp_lg_u32 s3, 0
    s_cbranch_scc1 L_sig_15
    s_lshr_b32 s61, s60, 5
    v_lshl_add_u32 v14, v1, 3, s61
    v_lshlrev_b32 v14, 15, v14
    s_and_b32 s61, s60, 31
    s_lshl_b32 s61, s61, 7
    s_add_u32 s61, s61, 16777232
    v_add_u32 v14, s61, v14
    v_mov_b32 v222, s78
    v_mov_b32 v223, s79
    s_mov_b32 exec_lo, 0xffffffff
    s_mov_b32 exec_hi, 0
    buffer_store_dwordx2 v[222:223], v14, s[40:43], 0 offen sc1
    s_mov_b64 exec, -1
    s_nop 1
L_sig_15:
    s_waitcnt lgkmcnt(4)
    v_mfma_f32_16x16x32_bf16 v[16:19], a[232:235], v[48:51], v[16:19]
    ds_read_b128 v[32:35], v120 offset:49152
    v_mfma_f32_16x16x32_bf16 v[20:23], a[232:235], v[52:55], v[20:23]
    ds_read_b128 v[36:39], v120 offset:51200
    v_mfma_f32_16x16x32_bf16 v[24:27], a[232:235], v[56:59], v[24:27]
    ds_read_b128 v[40:43], v120 offset:53248
    v_mfma_f32_16x16x32_bf16 v[28:31], a[232:235], v[60:63], v[28:31]
    ds_read_b128 v[44:47], v120 offset:55296
    s_waitcnt lgkmcnt(4)
    v_mfma_f32_16x16x32_bf16 v[16:19], a[236:239], v[144:147], v[16:19]
    ds_read_b128 v[48:51], v121 offset:49152
    v_mfma_f32_16x16x32_bf16 v[20:23], a[236:239], v[148:151], v[20:23]
    ds_read_b128 v[52:55], v121 offset:51200
    v_mfma_f32_16x16x32_bf16 v[24:27], a[236:239], v[152:155], v[24:27]
    ds_read_b128 v[56:59], v121 offset:53248
    v_mfma_f32_16x16x32_bf16 v[28:31], a[236:239], v[156:159], v[28:31]
    ds_read_b128 v[60:63], v121 offset:55296
    s_waitcnt lgkmcnt(4)
    v_mfma_f32_16x16x32_bf16 v[16:19], a[240:243], v[32:35], v[16:19]
    ds_read_b128 v[144:147], v120 offset:57344
    v_mfma_f32_16x16x32_bf16 v[20:23], a[240:243], v[36:39], v[20:23]
    ds_read_b128 v[148:151], v120 offset:59392
    v_mfma_f32_16x16x32_bf16 v[24:27], a[240:243], v[40:43], v[24:27]
    ds_read_b128 v[152:155], v120 offset:61440
    v_mfma_f32_16x16x32_bf16 v[28:31], a[240:243], v[44:47], v[28:31]
    ds_read_b128 v[156:159], v120 offset:63488
    s_waitcnt lgkmcnt(4)
    v_mfma_f32_16x16x32_bf16 v[16:19], a[244:247], v[48:51], v[16:19]
    ds_read_b128 v[32:35], v121 offset:57344
    v_mfma_f32_16x16x32_bf16 v[20:23], a[244:247], v[52:55], v[20:23]
    ds_read_b128 v[36:39], v121 offset:59392
    v_mfma_f32_16x16x32_bf16 v[24:27], a[244:247], v[56:59], v[24:27]
    ds_read_b128 v[40:43], v121 offset:61440
    v_mfma_f32_16x16x32_bf16 v[28:31], a[244:247], v[60:63], v[28:31]
    ds_read_b128 v[44:47], v121 offset:63488
    s_waitcnt lgkmcnt(4)
    v_mfma_f32_16x16x32_bf16 v[16:19], a[248:251], v[144:147], v[16:19]
    v_mfma_f32_16x16x32_bf16 v[20:23], a[248:251], v[148:151], v[20:23]
    v_mfma_f32_16x16x32_bf16 v[24:27], a[248:251], v[152:155], v[24:27]
    v_mfma_f32_16x16x32_bf16 v[28:31], a[248:251], v[156:159], v[28:31]
    s_waitcnt lgkmcnt(0)
    v_mfma_f32_16x16x32_bf16 v[16:19], a[252:255], v[32:35], v[16:19]
    v_mfma_f32_16x16x32_bf16 v[20:23], a[252:255], v[36:39], v[20:23]
    v_mfma_f32_16x16x32_bf16 v[24:27], a[252:255], v[40:43], v[24:27]
    v_mfma_f32_16x16x32_bf16 v[28:31], a[252:255], v[44:47], v[28:31]
    s_nop 4
    v_cvt_pk_bf16_f32 v16, v16, v17
    v_cvt_pk_bf16_f32 v18, v18, v19
    v_and_b32 v17, 0xffff0000, v16
    v_lshlrev_b32 v16, 16, v16
    v_and_b32 v19, 0xffff0000, v18
    v_lshlrev_b32 v18, 16, v18
    v_lshlrev_b32 v84, 16, v240
    v_and_b32 v85, 0xffff0000, v240
    v_lshlrev_b32 v86, 16, v241
    v_and_b32 v87, 0xffff0000, v241
    v_pk_add_f32 v[16:17], v[16:17], v[84:85]
    v_pk_add_f32 v[18:19], v[18:19], v[86:87]
    v_cvt_pk_bf16_f32 v64, v16, v17
    v_cvt_pk_bf16_f32 v65, v18, v19
    v_lshlrev_b32 v16, 16, v64
    v_and_b32 v17, 0xffff0000, v64
    v_lshlrev_b32 v18, 16, v65
    v_and_b32 v19, 0xffff0000, v65
    v_pk_add_f32 v[84:85], v[16:17], v[18:19]
    v_pk_mul_f32 v[86:87], v[16:17], v[16:17]
    v_pk_fma_f32 v[86:87], v[18:19], v[18:19], v[86:87]
    v_add_f32 v72, v84, v85
    v_add_f32 v73, v86, v87
    v_cvt_pk_bf16_f32 v20, v20, v21
    v_cvt_pk_bf16_f32 v22, v22, v23
    v_and_b32 v21, 0xffff0000, v20
    v_lshlrev_b32 v20, 16, v20
    v_and_b32 v23, 0xffff0000, v22
    v_lshlrev_b32 v22, 16, v22
    v_lshlrev_b32 v84, 16, v242
    v_and_b32 v85, 0xffff0000, v242
    v_lshlrev_b32 v86, 16, v243
    v_and_b32 v87, 0xffff0000, v243
    v_pk_add_f32 v[20:21], v[20:21], v[84:85]
    v_pk_add_f32 v[22:23], v[22:23], v[86:87]
    v_cvt_pk_bf16_f32 v64, v20, v21
    v_cvt_pk_bf16_f32 v65, v22, v23
    v_lshlrev_b32 v20, 16, v64
    v_and_b32 v21, 0xffff0000, v64
    v_lshlrev_b32 v22, 16, v65
    v_and_b32 v23, 0xffff0000, v65
    v_pk_add_f32 v[84:85], v[20:21], v[22:23]
    v_pk_mul_f32 v[86:87], v[20:21], v[20:21]
    v_pk_fma_f32 v[86:87], v[22:23], v[22:23], v[86:87]
    v_add_f32 v74, v84, v85
    v_add_f32 v75, v86, v87
    v_cvt_pk_bf16_f32 v24, v24, v25
    v_cvt_pk_bf16_f32 v26, v26, v27
    v_and_b32 v25, 0xffff0000, v24
    v_lshlrev_b32 v24, 16, v24
    v_and_b32 v27, 0xffff0000, v26
    v_lshlrev_b32 v26, 16, v26
    v_lshlrev_b32 v84, 16, v244
    v_and_b32 v85, 0xffff0000, v244
    v_lshlrev_b32 v86, 16, v245
    v_and_b32 v87, 0xffff0000, v245
    v_pk_add_f32 v[24:25], v[24:25], v[84:85]
    v_pk_add_f32 v[26:27], v[26:27], v[86:87]
    v_cvt_pk_bf16_f32 v64, v24, v25
    v_cvt_pk_bf16_f32 v65, v26, v27
    v_lshlrev_b32 v24, 16, v64
    v_and_b32 v25, 0xffff0000, v64
    v_lshlrev_b32 v26, 16, v65
    v_and_b32 v27, 0xffff0000, v65
    v_pk_add_f32 v[84:85], v[24:25], v[26:27]
    v_pk_mul_f32 v[86:87], v[24:25], v[24:25]
    v_pk_fma_f32 v[86:87], v[26:27], v[26:27], v[86:87]
    v_add_f32 v76, v84, v85
    v_add_f32 v77, v86, v87
    v_cvt_pk_bf16_f32 v28, v28, v29
    v_cvt_pk_bf16_f32 v30, v30, v31
    v_and_b32 v29, 0xffff0000, v28
    v_lshlrev_b32 v28, 16, v28
    v_and_b32 v31, 0xffff0000, v30
    v_lshlrev_b32 v30, 16, v30
    v_lshlrev_b32 v84, 16, v246
    v_and_b32 v85, 0xffff0000, v246
    v_lshlrev_b32 v86, 16, v247
    v_and_b32 v87, 0xffff0000, v247
    v_pk_add_f32 v[28:29], v[28:29], v[84:85]
    v_pk_add_f32 v[30:31], v[30:31], v[86:87]
    v_cvt_pk_bf16_f32 v64, v28, v29
    v_cvt_pk_bf16_f32 v65, v30, v31
    v_lshlrev_b32 v28, 16, v64
    v_and_b32 v29, 0xffff0000, v64
    v_lshlrev_b32 v30, 16, v65
    v_and_b32 v31, 0xffff0000, v65
    v_pk_add_f32 v[84:85], v[28:29], v[30:31]
    v_pk_mul_f32 v[86:87], v[28:29], v[28:29]
    v_pk_fma_f32 v[86:87], v[30:31], v[30:31], v[86:87]
    v_add_f32 v78, v84, v85
    v_add_f32 v79, v86, v87
    v_lshlrev_b32 v15, 9, v3
    v_lshl_add_u32 v15, v2, 3, v15
    s_lshl_b32 s61, s3, 11
    s_add_u32 s61, s61, 82944
    v_add_u32 v15, s61, v15
    ds_write_b64 v15, v[72:73] offset:0
    ds_write_b64 v15, v[74:75] offset:128
    ds_write_b64 v15, v[76:77] offset:256
    ds_write_b64 v15, v[78:79] offset:384
    s_waitcnt lgkmcnt(0)
    s_barrier
    s_lshl_b32 s61, s4, 3
    s_lshl_b32 s64, s3, 1
    s_add_u32 s61, s61, s64
    s_lshl_b32 s61, s61, 15
    s_lshl_b32 s64, s5, 10
    s_add_u32 s61, s61, s64
    s_add_u32 s61, s61, 16781312
    s_add_u32 s62, s61, 32768
    v_lshlrev_b32 v15, 3, v1
    v_add_u32 v15, 82944, v15
    ds_read_b64 v[84:85], v15 offset:0
    ds_read_b64 v[86:87], v15 offset:512
    ds_read_b64 v[88:89], v15 offset:1024
    ds_read_b64 v[90:91], v15 offset:1536
    ds_read_b64 v[92:93], v15 offset:2048
    ds_read_b64 v[94:95], v15 offset:2560
    ds_read_b64 v[96:97], v15 offset:3072
    ds_read_b64 v[98:99], v15 offset:3584
    s_waitcnt lgkmcnt(0)
    ds_read_b64 v[100:101], v15 offset:4096
    ds_read_b64 v[102:103], v15 offset:4608
    ds_read_b64 v[104:105], v15 offset:5120
    ds_read_b64 v[106:107], v15 offset:5632
    ds_read_b64 v[108:109], v15 offset:6144
    ds_read_b64 v[110:111], v15 offset:6656
    ds_read_b64 v[112:113], v15 offset:7168
    ds_read_b64 v[114:115], v15 offset:7680
    v_pk_add_f32 v[84:85], v[84:85], v[92:93]
    v_pk_add_f32 v[86:87], v[86:87], v[94:95]
    v_pk_add_f32 v[88:89], v[88:89], v[96:97]
    v_pk_add_f32 v[90:91], v[90:91], v[98:99]
    v_pk_add_f32 v[84:85], v[84:85], v[88:89]
    v_pk_add_f32 v[86:87], v[86:87], v[90:91]
    v_pk_add_f32 v[84:85], v[84:85], v[86:87]
    s_waitcnt lgkmcnt(0)
    v_pk_add_f32 v[100:101], v[100:101], v[108:109]
    v_pk_add_f32 v[102:103], v[102:103], v[110:111]
    v_pk_add_f32 v[104:105], v[104:105], v[112:113]
    v_pk_add_f32 v[106:107], v[106:107], v[114:115]
    v_pk_add_f32 v[100:101], v[100:101], v[104:105]
    v_pk_add_f32 v[102:103], v[102:103], v[106:107]
    v_pk_add_f32 v[100:101], v[100:101], v[102:103]
    v_pk_add_f32 v[84:85], v[84:85], v[100:101]
    v_mov_b32 v86, s78
    v_mov_b32 v87, s79
    s_cmp_lg_u32 s74, 0
    s_cbranch_scc1 L_sp_16
    buffer_store_dwordx4 v[84:87], v4, s[40:43], s61 offen sc1
    buffer_store_dwordx4 v[84:87], v4, s[40:43], s62 offen sc1
    s_branch L_se_17
L_sp_16:
    buffer_store_dwordx4 v[84:87], v4, s[40:43], s61 offen
    buffer_store_dwordx4 v[84:87], v4, s[40:43], s62 offen
L_se_17:
    s_add_u32 s61, s68, 4096
    s_lshl_b32 s62, s3, 11
    s_add_u32 s61, s61, s62
    s_nop 1
    s_branch L_pst0b
L_pst0a:
    s_sleep 1
L_pst0b:
    buffer_load_dwordx4 v[84:87], v4, s[40:43], s61 offen offset:0 sc1
    buffer_load_dwordx4 v[88:91], v4, s[40:43], s61 offen offset:1024 sc1
    s_waitcnt vmcnt(0)
    v_cmp_ne_u64 vcc, s[78:79], v[86:87]
    v_cmp_ne_u64 s[72:73], s[78:79], v[90:91]
    s_nop 0
    s_or_b64 vcc, vcc, s[72:73]
    s_cbranch_vccnz L_pst0a
    v_pk_add_f32 v[84:85], v[84:85], v[88:89]
    s_lshl_b32 s62, s3, 9
    s_add_u32 s62, s62, 95488
    v_lshl_add_u32 v14, v1, 3, s62
    ds_write_b64 v14, v[84:85]
    s_mov_b32 exec_lo, 0xffffffff
    s_mov_b32 exec_hi, 0
    s_add_u32 s61, s68, 16
    s_nop 1
L_poll_s3_18:
    buffer_load_dwordx2 v[222:223], v142, s[40:43], s61 offen sc1
    s_waitcnt vmcnt(0)
    v_cmp_ne_u64 vcc, s[78:79], v[222:223]
    s_cbranch_vccnz L_poll_s3_18
    s_mov_b64 exec, -1
    v_lshrrev_b32 v13, 3, v1
    v_lshlrev_b32 v13, 12, v13
    v_and_b32 v14, 7, v1
    v_lshl_add_u32 v13, v14, 4, v13
    s_lshl_b32 s61, s5, 18
    s_lshl_b32 s62, s4, 7
    s_add_u32 s61, s61, s62
    s_lshl_b32 s62, s3, 16
    s_add_u32 s61, s61, s62
    s_add_u32 s61, s61, 0
    s_lshl_b32 s62, s3, 11
    s_add_u32 m0, s62, 74752
    s_nop 0
    buffer_load_dwordx4 v13, s[40:43], s61 offen sc1 lds
    s_add_u32 s61, s61, 32768
    s_add_u32 m0, s62, 75776
    s_nop 0
    buffer_load_dwordx4 v13, s[40:43], s61 offen sc1 lds
    v_lshlrev_b32 v14, 3, v2
    v_add_u32 v14, 95488, v14
    s_waitcnt lgkmcnt(0)
    s_barrier
    ds_read_b64 v[84:85], v14 offset:0
    ds_read_b64 v[86:87], v14 offset:512
    ds_read_b64 v[88:89], v14 offset:1024
    ds_read_b64 v[90:91], v14 offset:1536
    ds_read_b64 v[92:93], v14 offset:128
    ds_read_b64 v[94:95], v14 offset:640
    ds_read_b64 v[96:97], v14 offset:1152
    ds_read_b64 v[98:99], v14 offset:1664
    ds_read_b64 v[100:101], v14 offset:256
    ds_read_b64 v[102:103], v14 offset:768
    ds_read_b64 v[104:105], v14 offset:1280
    ds_read_b64 v[106:107], v14 offset:1792
    ds_read_b64 v[108:109], v14 offset:384
    ds_read_b64 v[110:111], v14 offset:896
    ds_read_b64 v[112:113], v14 offset:1408
    ds_read_b64 v[114:115], v14 offset:1920
    s_waitcnt lgkmcnt(0)
    v_pk_add_f32 v[84:85], v[84:85], v[88:89]
    v_pk_add_f32 v[86:87], v[86:87], v[90:91]
    v_pk_add_f32 v[84:85], v[84:85], v[86:87]
    v_pk_add_f32 v[92:93], v[92:93], v[96:97]
    v_pk_add_f32 v[94:95], v[94:95], v[98:99]
    v_pk_add_f32 v[92:93], v[92:93], v[94:95]
    v_pk_add_f32 v[100:101], v[100:101], v[104:105]
    v_pk_add_f32 v[102:103], v[102:103], v[106:107]
    v_pk_add_f32 v[100:101], v[100:101], v[102:103]
    v_pk_add_f32 v[108:109], v[108:109], v[112:113]
    v_pk_add_f32 v[110:111], v[110:111], v[114:115]
    v_pk_add_f32 v[108:109], v[108:109], v[110:111]
    v_mul_f32 v88, 0x3b000000, v84
    v_mul_f32 v96, 0x3b000000, v92
    v_mul_f32 v104, 0x3b000000, v100
    v_mul_f32 v112, 0x3b000000, v108
    v_mul_f32 v89, 0x3b000000, v85
    v_mul_f32 v97, 0x3b000000, v93
    v_mul_f32 v105, 0x3b000000, v101
    v_mul_f32 v113, 0x3b000000, v109
    v_fma_f32 v89, -v88, v88, v89
    v_fma_f32 v97, -v96, v96, v97
    v_fma_f32 v105, -v104, v104, v105
    v_fma_f32 v113, -v112, v112, v113
    v_max_f32 v89, 0, v89
    v_max_f32 v97, 0, v97
    v_max_f32 v105, 0, v105
    v_max_f32 v113, 0, v113
    v_cvt_pk_bf16_f32 v88, v88, v89
    v_cvt_pk_bf16_f32 v96, v96, v97
    v_cvt_pk_bf16_f32 v104, v104, v105
    v_cvt_pk_bf16_f32 v112, v112, v113
    v_and_b32 v89, 0xffff0000, v88
    v_and_b32 v97, 0xffff0000, v96
    v_and_b32 v105, 0xffff0000, v104
    v_and_b32 v113, 0xffff0000, v112
    v_lshlrev_b32 v88, 16, v88
    v_lshlrev_b32 v96, 16, v96
    v_lshlrev_b32 v104, 16, v104
    v_lshlrev_b32 v112, 16, v112
    v_add_f32 v89, 0x3727c5ac, v89
    v_add_f32 v97, 0x3727c5ac, v97
    v_add_f32 v105, 0x3727c5ac, v105
    v_add_f32 v113, 0x3727c5ac, v113
    v_cvt_pk_bf16_f32 v89, v89, v89
    v_cvt_pk_bf16_f32 v97, v97, v97
    v_cvt_pk_bf16_f32 v105, v105, v105
    v_cvt_pk_bf16_f32 v113, v113, v113
    v_lshlrev_b32 v89, 16, v89
    v_lshlrev_b32 v97, 16, v97
    v_lshlrev_b32 v105, 16, v105
    v_lshlrev_b32 v113, 16, v113
    v_sqrt_f32 v89, v89
    v_sqrt_f32 v97, v97
    v_sqrt_f32 v105, v105
    v_sqrt_f32 v113, v113
    v_cvt_pk_bf16_f32 v89, v89, v89
    v_cvt_pk_bf16_f32 v97, v97, v97
    v_cvt_pk_bf16_f32 v105, v105, v105
    v_cvt_pk_bf16_f32 v113, v113, v113
    v_lshlrev_b32 v89, 16, v89
    v_lshlrev_b32 v97, 16, v97
    v_lshlrev_b32 v105, 16, v105
    v_lshlrev_b32 v113, 16, v113
    v_rcp_f32 v86, v89
    v_rcp_f32 v94, v97
    v_rcp_f32 v102, v105
    v_rcp_f32 v110, v113
    v_mul_f32 v87, -v88, v86
    v_mul_f32 v95, -v96, v94
    v_mul_f32 v103, -v104, v102
    v_mul_f32 v111, -v112, v110
    v_lshrrev_b32 v14, 2, v1
    v_lshlrev_b32 v14, 7, v14
    v_and_b32 v15, 3, v1
    v_lshl_add_u32 v14, v15, 3, v14
    s_lshl_b32 s61, s3, 11
    s_add_u32 s61, s61, 74752
    v_add_u32 v14, s61, v14
    s_waitcnt vmcnt(0)
    ds_read_b64_tr_b16 v[248:249], v14 offset:0
    ds_read_b64_tr_b16 v[250:251], v14 offset:32
    ds_read_b64_tr_b16 v[252:253], v14 offset:64
    ds_read_b64_tr_b16 v[254:255], v14 offset:96
    s_waitcnt lgkmcnt(0)
    v_lshlrev_b32 v32, 16, v248
    v_and_b32 v33, 0xffff0000, v248
    v_lshlrev_b32 v34, 16, v249
    v_and_b32 v35, 0xffff0000, v249
    v_pk_fma_f32 v[36:37], v[16:17], v[86:87], v[86:87] op_sel:[0,0,1] op_sel_hi:[1,0,1]
    v_pk_fma_f32 v[36:37], v[36:37], v[32:33], v[16:17]
    v_pk_fma_f32 v[38:39], v[18:19], v[86:87], v[86:87] op_sel:[0,0,1] op_sel_hi:[1,0,1]
    v_pk_fma_f32 v[38:39], v[38:39], v[34:35], v[18:19]
    v_cvt_pk_bf16_f32 v240, v36, v37
    v_cvt_pk_bf16_f32 v241, v38, v39
    v_lshlrev_b32 v40, 16, v250
    v_and_b32 v41, 0xffff0000, v250
    v_lshlrev_b32 v42, 16, v251
    v_and_b32 v43, 0xffff0000, v251
    v_pk_fma_f32 v[44:45], v[20:21], v[94:95], v[94:95] op_sel:[0,0,1] op_sel_hi:[1,0,1]
    v_pk_fma_f32 v[44:45], v[44:45], v[40:41], v[20:21]
    v_pk_fma_f32 v[46:47], v[22:23], v[94:95], v[94:95] op_sel:[0,0,1] op_sel_hi:[1,0,1]
    v_pk_fma_f32 v[46:47], v[46:47], v[42:43], v[22:23]
    v_cvt_pk_bf16_f32 v242, v44, v45
    v_cvt_pk_bf16_f32 v243, v46, v47
    v_lshlrev_b32 v48, 16, v252
    v_and_b32 v49, 0xffff0000, v252
    v_lshlrev_b32 v50, 16, v253
    v_and_b32 v51, 0xffff0000, v253
    v_pk_fma_f32 v[52:53], v[24:25], v[102:103], v[102:103] op_sel:[0,0,1] op_sel_hi:[1,0,1]
    v_pk_fma_f32 v[52:53], v[52:53], v[48:49], v[24:25]
    v_pk_fma_f32 v[54:55], v[26:27], v[102:103], v[102:103] op_sel:[0,0,1] op_sel_hi:[1,0,1]
    v_pk_fma_f32 v[54:55], v[54:55], v[50:51], v[26:27]
    v_cvt_pk_bf16_f32 v244, v52, v53
    v_cvt_pk_bf16_f32 v245, v54, v55
    v_lshlrev_b32 v56, 16, v254
    v_and_b32 v57, 0xffff0000, v254
    v_lshlrev_b32 v58, 16, v255
    v_and_b32 v59, 0xffff0000, v255
    v_pk_fma_f32 v[60:61], v[28:29], v[110:111], v[110:111] op_sel:[0,0,1] op_sel_hi:[1,0,1]
    v_pk_fma_f32 v[60:61], v[60:61], v[56:57], v[28:29]
    v_pk_fma_f32 v[62:63], v[30:31], v[110:111], v[110:111] op_sel:[0,0,1] op_sel_hi:[1,0,1]
    v_pk_fma_f32 v[62:63], v[62:63], v[58:59], v[30:31]
    v_cvt_pk_bf16_f32 v246, v60, v61
    v_cvt_pk_bf16_f32 v247, v62, v63
    v_lshrrev_b32 v13, 1, v3
    s_lshl_b32 s61, s3, 1
    v_add_u32 v13, s61, v13
    v_and_b32 v14, 7, v2
    v_xor_b32 v13, v13, v14
    v_lshlrev_b32 v13, 4, v13
    v_lshl_add_u32 v13, v2, 7, v13
    v_and_b32 v14, 1, v3
    v_lshl_add_u32 v13, v14, 3, v13
    v_add_u32 v13, 82944, v13
    ds_write_b64 v13, v[240:241] offset:0
    ds_write_b64 v13, v[242:243] offset:2048
    ds_write_b64 v13, v[244:245] offset:4096
    ds_write_b64 v13, v[246:247] offset:6144
    v_lshlrev_b32 v32, 16, v240
    v_and_b32 v33, 0xffff0000, v240
    v_lshlrev_b32 v34, 16, v241
    v_and_b32 v35, 0xffff0000, v241
    v_pk_add_f32 v[84:85], v[32:33], v[34:35]
    v_pk_mul_f32 v[86:87], v[32:33], v[32:33]
    v_pk_fma_f32 v[86:87], v[34:35], v[34:35], v[86:87]
    v_add_f32 v72, v84, v85
    v_add_f32 v73, v86, v87
    v_lshlrev_b32 v36, 16, v242
    v_and_b32 v37, 0xffff0000, v242
    v_lshlrev_b32 v38, 16, v243
    v_and_b32 v39, 0xffff0000, v243
    v_pk_add_f32 v[84:85], v[36:37], v[38:39]
    v_pk_mul_f32 v[86:87], v[36:37], v[36:37]
    v_pk_fma_f32 v[86:87], v[38:39], v[38:39], v[86:87]
    v_add_f32 v74, v84, v85
    v_add_f32 v75, v86, v87
    v_lshlrev_b32 v40, 16, v244
    v_and_b32 v41, 0xffff0000, v244
    v_lshlrev_b32 v42, 16, v245
    v_and_b32 v43, 0xffff0000, v245
    v_pk_add_f32 v[84:85], v[40:41], v[42:43]
    v_pk_mul_f32 v[86:87], v[40:41], v[40:41]
    v_pk_fma_f32 v[86:87], v[42:43], v[42:43], v[86:87]
    v_add_f32 v76, v84, v85
    v_add_f32 v77, v86, v87
    v_lshlrev_b32 v44, 16, v246
    v_and_b32 v45, 0xffff0000, v246
    v_lshlrev_b32 v46, 16, v247
    v_and_b32 v47, 0xffff0000, v247
    v_pk_add_f32 v[84:85], v[44:45], v[46:47]
    v_pk_mul_f32 v[86:87], v[44:45], v[44:45]
    v_pk_fma_f32 v[86:87], v[46:47], v[46:47], v[86:87]
    v_add_f32 v78, v84, v85
    v_add_f32 v79, v86, v87
    v_lshlrev_b32 v15, 9, v3
    v_lshl_add_u32 v15, v2, 3, v15
    s_lshl_b32 s61, s3, 11
    s_add_u32 s61, s61, 74752
    v_add_u32 v15, s61, v15
    ds_write_b64 v15, v[72:73] offset:0
    ds_write_b64 v15, v[74:75] offset:128
    ds_write_b64 v15, v[76:77] offset:256
    ds_write_b64 v15, v[78:79] offset:384
    v_lshlrev_b32 v14, 4, v0
    v_add_u32 v14, 82944, v14
    v_lshrrev_b32 v15, 3, v0
    v_xor_b32 v13, v0, v15
    v_and_b32 v13, 7, v13
    v_lshlrev_b32 v13, 4, v13
    v_lshl_add_u32 v13, v15, 10, v13
    s_waitcnt lgkmcnt(0)
    s_barrier
    ds_read_b128 v[144:147], v14 offset:0
    ds_read_b128 v[148:151], v14 offset:4096
    s_waitcnt lgkmcnt(0)
    s_add_u32 s62, s69, 32768
    s_cmp_lg_u32 s74, 0
    s_cbranch_scc1 L_sp_19
    buffer_store_dwordx4 v[144:147], v13, s[44:47], s69 offen sc1
    buffer_store_dwordx4 v[148:151], v13, s[44:47], s62 offen sc1
    s_branch L_se_20
L_sp_19:
    buffer_store_dwordx4 v[144:147], v13, s[44:47], s69 offen
    buffer_store_dwordx4 v[148:151], v13, s[44:47], s62 offen
L_se_20:
    s_lshl_b32 s70, s4, 14
    s_lshl_b32 s71, s5, 7
    s_add_u32 s70, s70, s71
    s_add_u32 s70, s70, 10485760
    s_cmp_ge_u32 s3, 2
    s_cselect_b32 s71, 4294950912, 0x40000000
    v_add_u32 v152, s71, v13
    v_lshlrev_b32 v15, 3, v1
    v_add_u32 v15, 74752, v15
    ds_read_b64 v[84:85], v15 offset:0
    ds_read_b64 v[86:87], v15 offset:512
    ds_read_b64 v[88:89], v15 offset:1024
    ds_read_b64 v[90:91], v15 offset:1536
    ds_read_b64 v[92:93], v15 offset:2048
    ds_read_b64 v[94:95], v15 offset:2560
    ds_read_b64 v[96:97], v15 offset:3072
    ds_read_b64 v[98:99], v15 offset:3584
    s_waitcnt lgkmcnt(0)
    ds_read_b64 v[100:101], v15 offset:4096
    ds_read_b64 v[102:103], v15 offset:4608
    ds_read_b64 v[104:105], v15 offset:5120
    ds_read_b64 v[106:107], v15 offset:5632
    ds_read_b64 v[108:109], v15 offset:6144
    ds_read_b64 v[110:111], v15 offset:6656
    ds_read_b64 v[112:113], v15 offset:7168
    ds_read_b64 v[114:115], v15 offset:7680
    v_pk_add_f32 v[84:85], v[84:85], v[92:93]
    v_pk_add_f32 v[86:87], v[86:87], v[94:95]
    v_pk_add_f32 v[88:89], v[88:89], v[96:97]
    v_pk_add_f32 v[90:91], v[90:91], v[98:99]
    v_pk_add_f32 v[84:85], v[84:85], v[88:89]
    v_pk_add_f32 v[86:87], v[86:87], v[90:91]
    v_pk_add_f32 v[84:85], v[84:85], v[86:87]
    s_waitcnt lgkmcnt(0)
    v_pk_add_f32 v[100:101], v[100:101], v[108:109]
    v_pk_add_f32 v[102:103], v[102:103], v[110:111]
    v_pk_add_f32 v[104:105], v[104:105], v[112:113]
    v_pk_add_f32 v[106:107], v[106:107], v[114:115]
    v_pk_add_f32 v[100:101], v[100:101], v[104:105]
    v_pk_add_f32 v[102:103], v[102:103], v[106:107]
    v_pk_add_f32 v[100:101], v[100:101], v[102:103]
    v_pk_add_f32 v[84:85], v[84:85], v[100:101]
    v_mov_b32 v86, s78
    v_mov_b32 v87, s79
    s_lshl_b32 s61, s4, 3
    s_lshl_b32 s64, s3, 1
    s_add_u32 s61, s61, s64
    s_lshl_b32 s61, s61, 15
    s_lshl_b32 s64, s5, 9
    s_add_u32 s61, s61, s64
    s_add_u32 s61, s61, 16789504
    s_add_u32 s62, s61, 32768
    s_lshl_b32 s63, s4, 3
    s_lshl_b32 s64, s3, 1
    s_add_u32 s63, s63, s64
    s_lshl_b32 s63, s63, 15
    s_lshl_b32 s64, s5, 7
    s_add_u32 s63, s63, s64
    s_add_u32 s63, s63, 17059456
    s_add_u32 s75, s63, 32768
    v_lshlrev_b32 v13, 3, v1
    s_cmp_lg_u32 s74, 0
    s_cbranch_scc1 L_sp_21
    buffer_store_dwordx2 v[84:85], v13, s[40:43], s61 offen sc1
    buffer_store_dwordx2 v[84:85], v13, s[40:43], s62 offen sc1
    s_branch L_se_22
L_sp_21:
    buffer_store_dwordx2 v[84:85], v13, s[40:43], s61 offen
    buffer_store_dwordx2 v[84:85], v13, s[40:43], s62 offen
L_se_22:
    buffer_store_dwordx4 v[148:151], v152, s[40:43], s70 offen sc1
    s_mov_b32 exec_lo, 0
    s_mov_b32 exec_hi, 0xffff0000
    buffer_store_dwordx2 v[84:85], v13, s[40:43], s63 offen sc1
    buffer_store_dwordx2 v[84:85], v13, s[40:43], s75 offen sc1
    s_mov_b64 exec, -1
    s_and_b32 s64, s3, 1
    s_lshl_b32 s81, s64, 6
    v_xor_b32 v197, s81, v143
    s_lshl_b32 s81, s64, 13
    v_add_u32 v197, s81, v197
    s_mul_i32 s70, s4, 4294918144
    s_add_u32 s70, s70, 10469376
    s_cmp_eq_u32 s4, 0
    s_cselect_b32 s70, 0x40000000, s70
    v_add_u32 v196, s70, v197
    v_add_u32 v198, 16384, v197
    v_add_u32 v199, 32768, v197
    v_add_u32 v200, 49152, v197
    s_lshr_b32 s81, s3, 1
    s_mul_i32 s81, s81, 10240
    s_lshl_b32 s64, s64, 10
    s_add_u32 s81, s81, s64
    v_mov_b32 v204, v141
    v_xor_b32 v205, 64, v141
    v_add_u32 v206, 40960, v204
    v_add_u32 v207, 40960, v205
    s_waitcnt vmcnt(3)
    s_barrier
    s_cmp_lg_u32 s3, 0
    s_cbranch_scc1 L_sig_23
    s_lshl_b32 s61, s4, 3
    v_add_u32 v14, s61, v1
    v_lshlrev_b32 v14, 15, v14
    s_lshl_b32 s61, s5, 7
    s_add_u32 s61, s61, 16801808
    v_add_u32 v14, s61, v14
    v_mov_b32 v222, s78
    v_mov_b32 v223, s79
    s_mov_b32 exec_lo, 0xff
    s_mov_b32 exec_hi, 0
    s_cmp_lg_u32 s74, 0
    s_cbranch_scc1 L_sp_24
    buffer_store_dwordx2 v[222:223], v14, s[40:43], 0 offen sc1
    s_branch L_se_25
L_sp_24:
    buffer_store_dwordx2 v[222:223], v14, s[40:43], 0 offen
L_se_25:
    s_mov_b64 exec, -1
    s_nop 1
L_sig_23:
    s_cmp_eq_u32 s4, 0
    s_cselect_b32 s63, 0, -1
    s_mov_b32 exec_lo, 0xff
    s_mov_b32 exec_hi, 0
    s_add_u32 s61, s68, 24592
    s_nop 1
L_poll_x2_26:
    buffer_load_dwordx2 v[222:223], v142, s[40:43], s61 offen sc1
    s_waitcnt vmcnt(0)
    v_cmp_ne_u64 vcc, s[78:79], v[222:223]
    s_cbranch_vccnz L_poll_x2_26
    s_mov_b64 exec, -1
    s_and_b32 s70, s3, 2
    s_add_u32 s70, s70, s6
    s_and_b32 s70, s70, 15
    s_lshl_b32 s70, s70, 6
    s_add_u32 m0, s81, 2048
    s_nop 0
    buffer_load_dwordx4 v197, s[44:47], s70 offen sc1 lds
    s_add_u32 m0, s81, 4096
    s_nop 0
    buffer_load_dwordx4 v198, s[44:47], s70 offen sc1 lds
    s_add_u32 m0, s81, 6144
    s_nop 0
    buffer_load_dwordx4 v199, s[44:47], s70 offen sc1 lds
    s_add_u32 m0, s81, 8192
    s_nop 0
    buffer_load_dwordx4 v200, s[44:47], s70 offen sc1 lds
    s_and_b32 s70, s3, 2
    s_add_u32 s70, s70, s6
    s_add_u32 s70, s70, 4
    s_and_b32 s70, s70, 15
    s_lshl_b32 s70, s70, 6
    s_add_u32 m0, s81, 22528
    s_nop 0
    buffer_load_dwordx4 v197, s[44:47], s70 offen sc1 lds
    s_add_u32 m0, s81, 24576
    s_nop 0
    buffer_load_dwordx4 v198, s[44:47], s70 offen sc1 lds
    s_add_u32 m0, s81, 26624
    s_nop 0
    buffer_load_dwordx4 v199, s[44:47], s70 offen sc1 lds
    s_add_u32 m0, s81, 28672
    s_nop 0
    buffer_load_dwordx4 v200, s[44:47], s70 offen sc1 lds
    v_lshlrev_b32 v13, 3, v1
    s_lshl_b32 s62, s3, 10
    s_add_u32 s61, s68, s62
    s_add_u32 s61, s61, 12288
    buffer_load_dwordx2 v[144:145], v13, s[40:43], s61 offen offset:0 sc1
    buffer_load_dwordx2 v[146:147], v13, s[40:43], s61 offen offset:512 sc1
    s_waitcnt vmcnt(6)
    s_barrier
    s_cmp_lg_u32 s3, 0
    s_cbranch_scc1 L_sig_27
    s_lshl_b32 s61, s4, 3
    s_add_u32 s61, s61, 8
    v_add_u32 v14, s61, v1
    v_lshlrev_b32 v14, 15, v14
    s_lshl_b32 s61, s5, 7
    s_add_u32 s61, s61, 16802832
    v_add_u32 v14, s61, v14
    v_mov_b32 v222, s78
    v_mov_b32 v223, s79
    s_mov_b32 exec_lo, 0xff
    s_mov_b32 exec_hi, 0
    buffer_store_dwordx2 v[222:223], v14, s[40:43], 0 offen sc1
    s_mov_b64 exec, -1
    s_nop 1
L_sig_27:
    ds_read_b128 v[84:87], v204 offset:2048
    ds_read_b128 v[88:91], v204 offset:4096
    ds_read_b128 v[92:95], v204 offset:6144
    ds_read_b128 v[96:99], v204 offset:8192
    ds_read_b128 v[100:103], v205 offset:2048
    ds_read_b128 v[104:107], v205 offset:4096
    ds_read_b128 v[108:111], v205 offset:6144
    ds_read_b128 v[112:115], v205 offset:8192
    s_waitcnt lgkmcnt(4)
    v_mfma_f32_16x16x32_bf16 v[36:39], a[4:7], v[84:87], 0
    s_and_b32 s70, s3, 2
    ds_read_b128 v[116:119], v204 offset:12288
    v_mfma_f32_16x16x32_bf16 v[56:59], v[84:87], a[8:11], 0
    s_add_u32 s70, s70, s6
    ds_read_b128 v[120:123], v204 offset:14336
    v_mfma_f32_16x16x32_bf16 v[16:19], a[0:3], v[84:87], 0
    s_add_u32 s70, s70, 8
    ds_read_b128 v[124:127], v204 offset:16384
    v_mfma_f32_16x16x32_bf16 v[40:43], a[4:7], v[88:91], 0
    s_and_b32 s70, s70, 15
    ds_read_b128 v[128:131], v204 offset:18432
    v_mfma_f32_16x16x32_bf16 v[60:63], v[88:91], a[8:11], 0
    s_lshl_b32 s70, s70, 6
    v_mfma_f32_16x16x32_bf16 v[20:23], a[0:3], v[88:91], 0
    s_add_u32 m0, s81, 43008
    s_nop 0
    buffer_load_dwordx4 v197, s[44:47], s70 offen sc1 lds
    v_mfma_f32_16x16x32_bf16 v[44:47], a[4:7], v[92:95], 0
    s_add_u32 m0, s81, 45056
    v_mfma_f32_16x16x32_bf16 v[64:67], v[92:95], a[8:11], 0
    buffer_load_dwordx4 v198, s[44:47], s70 offen sc1 lds
    v_mfma_f32_16x16x32_bf16 v[24:27], a[0:3], v[92:95], 0
    s_add_u32 m0, s81, 47104
    v_mfma_f32_16x16x32_bf16 v[48:51], a[4:7], v[96:99], 0
    buffer_load_dwordx4 v199, s[44:47], s70 offen sc1 lds
    v_mfma_f32_16x16x32_bf16 v[68:71], v[96:99], a[8:11], 0
    s_add_u32 m0, s81, 49152
    v_mfma_f32_16x16x32_bf16 v[28:31], a[0:3], v[96:99], 0
    buffer_load_dwordx4 v200, s[44:47], s70 offen sc1 lds
    s_waitcnt lgkmcnt(4)
    v_mfma_f32_16x16x32_bf16 v[36:39], a[16:19], v[100:103], v[36:39]
    ds_read_b128 v[84:87], v205 offset:12288
    v_mfma_f32_16x16x32_bf16 v[56:59], v[100:103], a[20:23], v[56:59]
    ds_read_b128 v[88:91], v205 offset:14336
    v_mfma_f32_16x16x32_bf16 v[16:19], a[12:15], v[100:103], v[16:19]
    ds_read_b128 v[92:95], v205 offset:16384
    v_mfma_f32_16x16x32_bf16 v[40:43], a[16:19], v[104:107], v[40:43]
    ds_read_b128 v[96:99], v205 offset:18432
    v_mfma_f32_16x16x32_bf16 v[60:63], v[104:107], a[20:23], v[60:63]
    v_mfma_f32_16x16x32_bf16 v[20:23], a[12:15], v[104:107], v[20:23]
    v_mfma_f32_16x16x32_bf16 v[44:47], a[16:19], v[108:111], v[44:47]
    v_mfma_f32_16x16x32_bf16 v[64:67], v[108:111], a[20:23], v[64:67]
    v_mfma_f32_16x16x32_bf16 v[24:27], a[12:15], v[108:111], v[24:27]
    v_mfma_f32_16x16x32_bf16 v[48:51], a[16:19], v[112:115], v[48:51]
    v_mfma_f32_16x16x32_bf16 v[68:71], v[112:115], a[20:23], v[68:71]
    v_mfma_f32_16x16x32_bf16 v[28:31], a[12:15], v[112:115], v[28:31]
    s_waitcnt vmcnt(6)
    s_barrier
    s_waitcnt lgkmcnt(4)
    v_mfma_f32_16x16x32_bf16 v[36:39], a[28:31], v[116:119], v[36:39]
    s_and_b32 s70, s3, 2
    ds_read_b128 v[100:103], v204 offset:22528
    v_mfma_f32_16x16x32_bf16 v[56:59], v[116:119], a[32:35], v[56:59]
    s_add_u32 s70, s70, s6
    ds_read_b128 v[104:107], v204 offset:24576
    v_mfma_f32_16x16x32_bf16 v[16:19], a[24:27], v[116:119], v[16:19]
    s_add_u32 s70, s70, 12
    ds_read_b128 v[108:111], v204 offset:26624
    v_mfma_f32_16x16x32_bf16 v[40:43], a[28:31], v[120:123], v[40:43]
    s_and_b32 s70, s70, 15
    ds_read_b128 v[112:115], v204 offset:28672
    v_mfma_f32_16x16x32_bf16 v[60:63], v[120:123], a[32:35], v[60:63]
    s_lshl_b32 s70, s70, 6
    v_mfma_f32_16x16x32_bf16 v[20:23], a[24:27], v[120:123], v[20:23]
    s_add_u32 m0, s81, 63488
    s_nop 0
    buffer_load_dwordx4 v197, s[44:47], s70 offen sc1 lds
    v_mfma_f32_16x16x32_bf16 v[44:47], a[28:31], v[124:127], v[44:47]
    s_add_u32 m0, s81, 65536
    v_mfma_f32_16x16x32_bf16 v[64:67], v[124:127], a[32:35], v[64:67]
    buffer_load_dwordx4 v198, s[44:47], s70 offen sc1 lds
    v_mfma_f32_16x16x32_bf16 v[24:27], a[24:27], v[124:127], v[24:27]
    s_add_u32 m0, s81, 67584
    v_mfma_f32_16x16x32_bf16 v[48:51], a[28:31], v[128:131], v[48:51]
    buffer_load_dwordx4 v199, s[44:47], s70 offen sc1 lds
    v_mfma_f32_16x16x32_bf16 v[68:71], v[128:131], a[32:35], v[68:71]
    s_add_u32 m0, s81, 69632
    v_mfma_f32_16x16x32_bf16 v[28:31], a[24:27], v[128:131], v[28:31]
    buffer_load_dwordx4 v200, s[44:47], s70 offen sc1 lds
    s_waitcnt lgkmcnt(4)
    v_mfma_f32_16x16x32_bf16 v[36:39], a[40:43], v[84:87], v[36:39]
    ds_read_b128 v[116:119], v205 offset:22528
    v_mfma_f32_16x16x32_bf16 v[56:59], v[84:87], a[44:47], v[56:59]
    ds_read_b128 v[120:123], v205 offset:24576
    v_mfma_f32_16x16x32_bf16 v[16:19], a[36:39], v[84:87], v[16:19]
    ds_read_b128 v[124:127], v205 offset:26624
    v_mfma_f32_16x16x32_bf16 v[40:43], a[40:43], v[88:91], v[40:43]
    ds_read_b128 v[128:131], v205 offset:28672
    v_mfma_f32_16x16x32_bf16 v[60:63], v[88:91], a[44:47], v[60:63]
    v_mfma_f32_16x16x32_bf16 v[20:23], a[36:39], v[88:91], v[20:23]
    v_mfma_f32_16x16x32_bf16 v[44:47], a[40:43], v[92:95], v[44:47]
    v_mfma_f32_16x16x32_bf16 v[64:67], v[92:95], a[44:47], v[64:67]
    v_mfma_f32_16x16x32_bf16 v[24:27], a[36:39], v[92:95], v[24:27]
    v_mfma_f32_16x16x32_bf16 v[48:51], a[40:43], v[96:99], v[48:51]
    v_mfma_f32_16x16x32_bf16 v[68:71], v[96:99], a[44:47], v[68:71]
    v_mfma_f32_16x16x32_bf16 v[28:31], a[36:39], v[96:99], v[28:31]
    s_waitcnt lgkmcnt(4)
    v_mfma_f32_16x16x32_bf16 v[36:39], a[52:55], v[100:103], v[36:39]
    ds_read_b128 v[84:87], v204 offset:32768
    v_mfma_f32_16x16x32_bf16 v[56:59], v[100:103], a[56:59], v[56:59]
    ds_read_b128 v[88:91], v204 offset:34816
    v_mfma_f32_16x16x32_bf16 v[16:19], a[48:51], v[100:103], v[16:19]
    ds_read_b128 v[92:95], v204 offset:36864
    v_mfma_f32_16x16x32_bf16 v[40:43], a[52:55], v[104:107], v[40:43]
    ds_read_b128 v[96:99], v204 offset:38912
    v_mfma_f32_16x16x32_bf16 v[60:63], v[104:107], a[56:59], v[60:63]
    v_mfma_f32_16x16x32_bf16 v[20:23], a[48:51], v[104:107], v[20:23]
    v_mfma_f32_16x16x32_bf16 v[44:47], a[52:55], v[108:111], v[44:47]
    v_mfma_f32_16x16x32_bf16 v[64:67], v[108:111], a[56:59], v[64:67]
    v_mfma_f32_16x16x32_bf16 v[24:27], a[48:51], v[108:111], v[24:27]
    v_mfma_f32_16x16x32_bf16 v[48:51], a[52:55], v[112:115], v[48:51]
    v_mfma_f32_16x16x32_bf16 v[68:71], v[112:115], a[56:59], v[68:71]
    v_mfma_f32_16x16x32_bf16 v[28:31], a[48:51], v[112:115], v[28:31]
    s_waitcnt lgkmcnt(4)
    v_mfma_f32_16x16x32_bf16 v[36:39], a[64:67], v[116:119], v[36:39]
    ds_read_b128 v[100:103], v205 offset:32768
    v_mfma_f32_16x16x32_bf16 v[56:59], v[116:119], a[68:71], v[56:59]
    ds_read_b128 v[104:107], v205 offset:34816
    v_mfma_f32_16x16x32_bf16 v[16:19], a[60:63], v[116:119], v[16:19]
    ds_read_b128 v[108:111], v205 offset:36864
    v_mfma_f32_16x16x32_bf16 v[40:43], a[64:67], v[120:123], v[40:43]
    ds_read_b128 v[112:115], v205 offset:38912
    v_mfma_f32_16x16x32_bf16 v[60:63], v[120:123], a[68:71], v[60:63]
    v_mfma_f32_16x16x32_bf16 v[20:23], a[60:63], v[120:123], v[20:23]
    v_mfma_f32_16x16x32_bf16 v[44:47], a[64:67], v[124:127], v[44:47]
    v_mfma_f32_16x16x32_bf16 v[64:67], v[124:127], a[68:71], v[64:67]
    v_mfma_f32_16x16x32_bf16 v[24:27], a[60:63], v[124:127], v[24:27]
    v_mfma_f32_16x16x32_bf16 v[48:51], a[64:67], v[128:131], v[48:51]
    v_mfma_f32_16x16x32_bf16 v[68:71], v[128:131], a[68:71], v[68:71]
    v_mfma_f32_16x16x32_bf16 v[28:31], a[60:63], v[128:131], v[28:31]
    s_waitcnt vmcnt(4)
    s_barrier
    s_waitcnt lgkmcnt(4)
    v_mfma_f32_16x16x32_bf16 v[36:39], a[76:79], v[84:87], v[36:39]
    ds_read_b128 v[116:119], v206 offset:2048
    v_mfma_f32_16x16x32_bf16 v[56:59], v[84:87], a[80:83], v[56:59]
    ds_read_b128 v[120:123], v206 offset:4096
    v_mfma_f32_16x16x32_bf16 v[16:19], a[72:75], v[84:87], v[16:19]
    ds_read_b128 v[124:127], v206 offset:6144
    v_mfma_f32_16x16x32_bf16 v[40:43], a[76:79], v[88:91], v[40:43]
    ds_read_b128 v[128:131], v206 offset:8192
    v_mfma_f32_16x16x32_bf16 v[60:63], v[88:91], a[80:83], v[60:63]
    v_mfma_f32_16x16x32_bf16 v[20:23], a[72:75], v[88:91], v[20:23]
    v_mfma_f32_16x16x32_bf16 v[44:47], a[76:79], v[92:95], v[44:47]
    v_mfma_f32_16x16x32_bf16 v[64:67], v[92:95], a[80:83], v[64:67]
    v_mfma_f32_16x16x32_bf16 v[24:27], a[72:75], v[92:95], v[24:27]
    v_mfma_f32_16x16x32_bf16 v[48:51], a[76:79], v[96:99], v[48:51]
    v_mfma_f32_16x16x32_bf16 v[68:71], v[96:99], a[80:83], v[68:71]
    v_mfma_f32_16x16x32_bf16 v[28:31], a[72:75], v[96:99], v[28:31]
    s_waitcnt lgkmcnt(4)
    v_mfma_f32_16x16x32_bf16 v[36:39], a[88:91], v[100:103], v[36:39]
    ds_read_b128 v[84:87], v207 offset:2048
    v_mfma_f32_16x16x32_bf16 v[56:59], v[100:103], a[92:95], v[56:59]
    ds_read_b128 v[88:91], v207 offset:4096
    v_mfma_f32_16x16x32_bf16 v[16:19], a[84:87], v[100:103], v[16:19]
    ds_read_b128 v[92:95], v207 offset:6144
    v_mfma_f32_16x16x32_bf16 v[40:43], a[88:91], v[104:107], v[40:43]
    ds_read_b128 v[96:99], v207 offset:8192
    v_mfma_f32_16x16x32_bf16 v[60:63], v[104:107], a[92:95], v[60:63]
    v_mfma_f32_16x16x32_bf16 v[20:23], a[84:87], v[104:107], v[20:23]
    v_mfma_f32_16x16x32_bf16 v[44:47], a[88:91], v[108:111], v[44:47]
    v_mfma_f32_16x16x32_bf16 v[64:67], v[108:111], a[92:95], v[64:67]
    v_mfma_f32_16x16x32_bf16 v[24:27], a[84:87], v[108:111], v[24:27]
    v_mfma_f32_16x16x32_bf16 v[48:51], a[88:91], v[112:115], v[48:51]
    v_mfma_f32_16x16x32_bf16 v[68:71], v[112:115], a[92:95], v[68:71]
    v_mfma_f32_16x16x32_bf16 v[28:31], a[84:87], v[112:115], v[28:31]
    s_waitcnt lgkmcnt(4)
    v_mfma_f32_16x16x32_bf16 v[36:39], a[100:103], v[116:119], v[36:39]
    ds_read_b128 v[100:103], v206 offset:12288
    v_mfma_f32_16x16x32_bf16 v[56:59], v[116:119], a[104:107], v[56:59]
    ds_read_b128 v[104:107], v206 offset:14336
    v_mfma_f32_16x16x32_bf16 v[16:19], a[96:99], v[116:119], v[16:19]
    ds_read_b128 v[108:111], v206 offset:16384
    v_mfma_f32_16x16x32_bf16 v[40:43], a[100:103], v[120:123], v[40:43]
    ds_read_b128 v[112:115], v206 offset:18432
    v_mfma_f32_16x16x32_bf16 v[60:63], v[120:123], a[104:107], v[60:63]
    v_mfma_f32_16x16x32_bf16 v[20:23], a[96:99], v[120:123], v[20:23]
    v_mfma_f32_16x16x32_bf16 v[44:47], a[100:103], v[124:127], v[44:47]
    v_mfma_f32_16x16x32_bf16 v[64:67], v[124:127], a[104:107], v[64:67]
    v_mfma_f32_16x16x32_bf16 v[24:27], a[96:99], v[124:127], v[24:27]
    v_mfma_f32_16x16x32_bf16 v[48:51], a[100:103], v[128:131], v[48:51]
    v_mfma_f32_16x16x32_bf16 v[68:71], v[128:131], a[104:107], v[68:71]
    v_mfma_f32_16x16x32_bf16 v[28:31], a[96:99], v[128:131], v[28:31]
    s_waitcnt lgkmcnt(4)
    v_mfma_f32_16x16x32_bf16 v[36:39], a[112:115], v[84:87], v[36:39]
    ds_read_b128 v[116:119], v207 offset:12288
    v_mfma_f32_16x16x32_bf16 v[56:59], v[84:87], a[116:119], v[56:59]
    ds_read_b128 v[120:123], v207 offset:14336
    v_mfma_f32_16x16x32_bf16 v[16:19], a[108:111], v[84:87], v[16:19]
    ds_read_b128 v[124:127], v207 offset:16384
    v_mfma_f32_16x16x32_bf16 v[40:43], a[112:115], v[88:91], v[40:43]
    s_add_u32 s70, s68, 25616
    ds_read_b128 v[128:131], v207 offset:18432
    v_mfma_f32_16x16x32_bf16 v[60:63], v[88:91], a[116:119], v[60:63]
    v_mfma_f32_16x16x32_bf16 v[20:23], a[108:111], v[88:91], v[20:23]
    v_mfma_f32_16x16x32_bf16 v[44:47], a[112:115], v[92:95], v[44:47]
    v_mfma_f32_16x16x32_bf16 v[64:67], v[92:95], a[116:119], v[64:67]
    buffer_load_dwordx2 v[214:215], v142, s[40:43], s70 offen sc1
    v_mfma_f32_16x16x32_bf16 v[24:27], a[108:111], v[92:95], v[24:27]
    v_mfma_f32_16x16x32_bf16 v[48:51], a[112:115], v[96:99], v[48:51]
    v_mfma_f32_16x16x32_bf16 v[68:71], v[96:99], a[116:119], v[68:71]
    v_mfma_f32_16x16x32_bf16 v[28:31], a[108:111], v[96:99], v[28:31]
    v_add_f32 v144, v144, v146
    v_add_f32 v145, v145, v147
    s_mul_i32 s62, s3, 640
    s_add_u32 s62, s62, 95488
    v_lshl_add_u32 v14, v1, 3, s62
    ds_write_b64 v14, v[144:145] offset:128
    s_waitcnt lgkmcnt(0)
    s_waitcnt vmcnt(1)
    s_barrier
    v_mfma_f32_16x16x32_bf16 v[36:39], a[124:127], v[100:103], v[36:39]
    ds_read_b128 v[84:87], v206 offset:22528
    v_mfma_f32_16x16x32_bf16 v[56:59], v[100:103], a[128:131], v[56:59]
    ds_read_b128 v[88:91], v206 offset:24576
    v_mfma_f32_16x16x32_bf16 v[16:19], a[120:123], v[100:103], v[16:19]
    ds_read_b128 v[92:95], v206 offset:26624
    v_mfma_f32_16x16x32_bf16 v[40:43], a[124:127], v[104:107], v[40:43]
    ds_read_b128 v[96:99], v206 offset:28672
    v_mfma_f32_16x16x32_bf16 v[60:63], v[104:107], a[128:131], v[60:63]
    v_mfma_f32_16x16x32_bf16 v[20:23], a[120:123], v[104:107], v[20:23]
    v_mfma_f32_16x16x32_bf16 v[44:47], a[124:127], v[108:111], v[44:47]
    v_mfma_f32_16x16x32_bf16 v[64:67], v[108:111], a[128:131], v[64:67]
    v_mfma_f32_16x16x32_bf16 v[24:27], a[120:123], v[108:111], v[24:27]
    v_mfma_f32_16x16x32_bf16 v[48:51], a[124:127], v[112:115], v[48:51]
    v_mfma_f32_16x16x32_bf16 v[68:71], v[112:115], a[128:131], v[68:71]
    v_mfma_f32_16x16x32_bf16 v[28:31], a[120:123], v[112:115], v[28:31]
    s_waitcnt vmcnt(0)
    s_cmp_eq_u32 s4, 0
    s_cbranch_scc1 L_h0_28
    s_mov_b32 exec_lo, 0xff
    s_mov_b32 exec_hi, 0
    v_cmp_ne_u64 vcc, s[78:79], v[214:215]
    s_mov_b64 exec, -1
    s_cbranch_vccz L_achk_29
    s_mov_b32 exec_lo, 0xff
    s_mov_b32 exec_hi, 0
    s_add_u32 s61, s68, 25616
    s_nop 1
L_poll_halo_30:
    buffer_load_dwordx2 v[222:223], v142, s[40:43], s61 offen sc1
    s_waitcnt vmcnt(0)
    v_cmp_ne_u64 vcc, s[78:79], v[222:223]
    s_cbranch_vccnz L_poll_halo_30
    s_mov_b64 exec, -1
    s_nop 2
L_achk_29:
L_h0_28:
    s_xor_b32 s78, s78, 1
    v_mfma_f32_16x16x32_bf16 v[36:39], a[136:139], v[116:119], v[36:39]
    s_and_b32 s70, s3, 2
    ds_read_b128 v[100:103], v207 offset:22528
    v_mfma_f32_16x16x32_bf16 v[56:59], v[116:119], a[140:143], v[56:59]
    s_add_u32 s70, s70, s6
    ds_read_b128 v[104:107], v207 offset:24576
    v_mfma_f32_16x16x32_bf16 v[16:19], a[132:135], v[116:119], v[16:19]
    s_and_b32 s70, s70, 15
    ds_read_b128 v[108:111], v207 offset:26624
    v_mfma_f32_16x16x32_bf16 v[40:43], a[136:139], v[120:123], v[40:43]
    s_lshl_b32 s70, s70, 6
    ds_read_b128 v[112:115], v207 offset:28672
    v_mfma_f32_16x16x32_bf16 v[60:63], v[120:123], a[140:143], v[60:63]
    s_add_u32 m0, s81, 0
    v_mfma_f32_16x16x32_bf16 v[20:23], a[132:135], v[120:123], v[20:23]
    buffer_load_dwordx4 v196, s[40:43], s70 offen sc1 lds
    v_mfma_f32_16x16x32_bf16 v[44:47], a[136:139], v[124:127], v[44:47]
    v_lshlrev_b32 v158, 3, v1
    v_mfma_f32_16x16x32_bf16 v[64:67], v[124:127], a[140:143], v[64:67]
    v_add_u32 v158, 95488, v158
    v_mfma_f32_16x16x32_bf16 v[24:27], a[132:135], v[124:127], v[24:27]
    ds_read_b64 v[144:145], v158 offset:128
    v_mfma_f32_16x16x32_bf16 v[48:51], a[136:139], v[128:131], v[48:51]
    ds_read_b64 v[146:147], v158 offset:768
    v_mfma_f32_16x16x32_bf16 v[68:71], v[128:131], a[140:143], v[68:71]
    ds_read_b64 v[148:149], v158 offset:1408
    v_mfma_f32_16x16x32_bf16 v[28:31], a[132:135], v[128:131], v[28:31]
    ds_read_b64 v[150:151], v158 offset:2048
    s_waitcnt lgkmcnt(8)
    v_mfma_f32_16x16x32_bf16 v[36:39], a[148:151], v[84:87], v[36:39]
    ds_read_b128 v[116:119], v206 offset:32768
    v_mfma_f32_16x16x32_bf16 v[56:59], v[84:87], a[152:155], v[56:59]
    s_and_b32 s70, s3, 2
    ds_read_b128 v[120:123], v206 offset:34816
    v_mfma_f32_16x16x32_bf16 v[16:19], a[144:147], v[84:87], v[16:19]
    s_add_u32 s70, s70, s6
    ds_read_b128 v[124:127], v206 offset:36864
    v_mfma_f32_16x16x32_bf16 v[40:43], a[148:151], v[88:91], v[40:43]
    ds_read_b128 v[128:131], v206 offset:38912
    v_mfma_f32_16x16x32_bf16 v[60:63], v[88:91], a[152:155], v[60:63]
    s_add_u32 s70, s70, 4
    v_mfma_f32_16x16x32_bf16 v[20:23], a[144:147], v[88:91], v[20:23]
    s_and_b32 s70, s70, 15
    v_mfma_f32_16x16x32_bf16 v[44:47], a[148:151], v[92:95], v[44:47]
    v_mfma_f32_16x16x32_bf16 v[64:67], v[92:95], a[152:155], v[64:67]
    s_lshl_b32 s70, s70, 6
    v_mfma_f32_16x16x32_bf16 v[24:27], a[144:147], v[92:95], v[24:27]
    s_add_u32 m0, s81, 20480
    v_mfma_f32_16x16x32_bf16 v[48:51], a[148:151], v[96:99], v[48:51]
    v_mfma_f32_16x16x32_bf16 v[68:71], v[96:99], a[152:155], v[68:71]
    buffer_load_dwordx4 v196, s[40:43], s70 offen sc1 lds
    v_mfma_f32_16x16x32_bf16 v[28:31], a[144:147], v[96:99], v[28:31]
    s_waitcnt lgkmcnt(8)
    v_mfma_f32_16x16x32_bf16 v[36:39], a[160:163], v[100:103], v[36:39]
    ds_read_b128 v[84:87], v207 offset:32768
    v_mfma_f32_16x16x32_bf16 v[56:59], v[100:103], a[164:167], v[56:59]
    s_and_b32 s70, s3, 2
    ds_read_b128 v[88:91], v207 offset:34816
    v_mfma_f32_16x16x32_bf16 v[16:19], a[156:159], v[100:103], v[16:19]
    s_add_u32 s70, s70, s6
    ds_read_b128 v[92:95], v207 offset:36864
    v_mfma_f32_16x16x32_bf16 v[40:43], a[160:163], v[104:107], v[40:43]
    ds_read_b128 v[96:99], v207 offset:38912
    v_mfma_f32_16x16x32_bf16 v[60:63], v[104:107], a[164:167], v[60:63]
    s_add_u32 s70, s70, 8
    v_mfma_f32_16x16x32_bf16 v[20:23], a[156:159], v[104:107], v[20:23]
    s_and_b32 s70, s70, 15
    v_mfma_f32_16x16x32_bf16 v[44:47], a[160:163], v[108:111], v[44:47]
    v_mfma_f32_16x16x32_bf16 v[64:67], v[108:111], a[164:167], v[64:67]
    s_lshl_b32 s70, s70, 6
    v_mfma_f32_16x16x32_bf16 v[24:27], a[156:159], v[108:111], v[24:27]
    s_add_u32 m0, s81, 40960
    v_mfma_f32_16x16x32_bf16 v[48:51], a[160:163], v[112:115], v[48:51]
    v_mfma_f32_16x16x32_bf16 v[68:71], v[112:115], a[164:167], v[68:71]
    buffer_load_dwordx4 v196, s[40:43], s70 offen sc1 lds
    v_mfma_f32_16x16x32_bf16 v[28:31], a[156:159], v[112:115], v[28:31]
    s_waitcnt lgkmcnt(4)
    v_mfma_f32_16x16x32_bf16 v[36:39], a[172:175], v[116:119], v[36:39]
    s_and_b32 s70, s3, 2
    s_add_u32 s70, s70, s6
    v_mfma_f32_16x16x32_bf16 v[56:59], v[116:119], a[176:179], v[56:59]
    s_add_u32 s70, s70, 12
    s_and_b32 s70, s70, 15
    v_mfma_f32_16x16x32_bf16 v[16:19], a[168:171], v[116:119], v[16:19]
    s_lshl_b32 s70, s70, 6
    s_add_u32 m0, s81, 61440
    v_mfma_f32_16x16x32_bf16 v[40:43], a[172:175], v[120:123], v[40:43]
    buffer_load_dwordx4 v196, s[40:43], s70 offen sc1 lds
    v_lshlrev_b32 v217, 3, v1
    v_mfma_f32_16x16x32_bf16 v[60:63], v[120:123], a[176:179], v[60:63]
    s_lshl_b32 s70, s3, 8
    s_add_u32 s70, s70, s68
    v_mfma_f32_16x16x32_bf16 v[20:23], a[168:171], v[120:123], v[20:23]
    s_add_u32 s70, s70, 20480
    buffer_load_dwordx2 v[208:209], v217, s[40:43], s70 offen sc1
    v_add_f32 v144, v144, v146
    v_mfma_f32_16x16x32_bf16 v[44:47], a[172:175], v[124:127], v[44:47]
    v_add_f32 v145, v145, v147
    v_add_f32 v148, v148, v150
    v_mfma_f32_16x16x32_bf16 v[64:67], v[124:127], a[176:179], v[64:67]
    v_add_f32 v149, v149, v151
    v_add_f32 v144, v144, v148
    v_mfma_f32_16x16x32_bf16 v[24:27], a[168:171], v[124:127], v[24:27]
    v_add_f32 v145, v145, v149
    v_mul_f32 v156, 0x3b000000, v144
    v_mfma_f32_16x16x32_bf16 v[48:51], a[172:175], v[128:131], v[48:51]
    v_mul_f32 v157, 0x3b000000, v145
    v_fma_f32 v157, -v156, v156, v157
    v_mfma_f32_16x16x32_bf16 v[68:71], v[128:131], a[176:179], v[68:71]
    v_max_f32 v157, 0, v157
    v_cvt_pk_bf16_f32 v156, v156, v157
    v_mfma_f32_16x16x32_bf16 v[28:31], a[168:171], v[128:131], v[28:31]
    v_and_b32 v157, 0xffff0000, v156
    v_lshlrev_b32 v156, 16, v156
    s_waitcnt lgkmcnt(0)
    v_mfma_f32_16x16x32_bf16 v[36:39], a[184:187], v[84:87], v[36:39]
    v_add_f32 v157, 0x3727c5ac, v157
    v_mfma_f32_16x16x32_bf16 v[56:59], v[84:87], a[188:191], v[56:59]
    v_cvt_pk_bf16_f32 v157, v157, v157
    v_mfma_f32_16x16x32_bf16 v[16:19], a[180:183], v[84:87], v[16:19]
    v_lshlrev_b32 v157, 16, v157
    v_mfma_f32_16x16x32_bf16 v[40:43], a[184:187], v[88:91], v[40:43]
    v_sqrt_f32 v157, v157
    v_mfma_f32_16x16x32_bf16 v[60:63], v[88:91], a[188:191], v[60:63]
    v_cvt_pk_bf16_f32 v157, v157, v157
    v_mfma_f32_16x16x32_bf16 v[20:23], a[180:183], v[88:91], v[20:23]
    v_lshlrev_b32 v157, 16, v157
    v_mfma_f32_16x16x32_bf16 v[44:47], a[184:187], v[92:95], v[44:47]
    v_rcp_f32 v154, v157
    v_mfma_f32_16x16x32_bf16 v[64:67], v[92:95], a[188:191], v[64:67]
    v_mul_f32 v155, -v156, v154
    v_mfma_f32_16x16x32_bf16 v[24:27], a[180:183], v[92:95], v[24:27]
    s_mul_i32 s71, s3, 640
    v_mfma_f32_16x16x32_bf16 v[48:51], a[184:187], v[96:99], v[48:51]
    s_add_u32 s71, s71, 92416
    v_mfma_f32_16x16x32_bf16 v[68:71], v[96:99], a[188:191], v[68:71]
    v_lshl_add_u32 v158, v1, 2, s71
    v_mfma_f32_16x16x32_bf16 v[28:31], a[180:183], v[96:99], v[28:31]
    ds_write2_b32 v158, v154, v155 offset0:16 offset1:96
    s_waitcnt vmcnt(0)
    v_and_b32 v208, s63, v208
    v_and_b32 v209, s63, v209
    v_mov_b32 v210, v208
    v_mov_b32 v211, v209
    s_nop 0
    v_permlane16_swap_b32 v208, v210
    v_permlane16_swap_b32 v209, v211
    v_add_f32 v208, v208, v210
    v_add_f32 v209, v209, v211
    s_mul_i32 s62, s3, 640
    s_add_u32 s62, s62, 95488
    v_lshl_add_u32 v14, v1, 3, s62
    s_mov_b32 exec_lo, 0xffff
    s_mov_b32 exec_hi, 0
    ds_write_b64 v14, v[208:209]
    s_mov_b64 exec, -1
    s_waitcnt lgkmcnt(0)
    s_barrier
    ds_read_b128 v[84:87], v204 offset:0
    ds_read_b128 v[88:91], v205 offset:0
    ds_read_b128 v[92:95], v204 offset:10240
    ds_read_b128 v[96:99], v205 offset:10240
    ds_read_b128 v[100:103], v204 offset:20480
    ds_read_b128 v[104:107], v205 offset:20480
    s_waitcnt lgkmcnt(5)
    v_mfma_f32_16x16x32_bf16 v[32:35], a[4:7], v[84:87], 0
    v_lshlrev_b32 v158, 3, v2
    v_add_u32 v158, 95488, v158
    ds_read_b64 v[144:145], v158 offset:0
    ds_read_b128 v[108:111], v204 offset:30720
    v_mfma_f32_16x16x32_bf16 v[52:55], v[84:87], a[8:11], 0
    ds_read_b64 v[146:147], v158 offset:640
    ds_read_b64 v[148:149], v158 offset:1280
    ds_read_b64 v[150:151], v158 offset:1920
    s_waitcnt lgkmcnt(9)
    v_mfma_f32_16x16x32_bf16 v[32:35], a[16:19], v[88:91], v[32:35]
    ds_read_b128 v[84:87], v205 offset:30720
    v_mfma_f32_16x16x32_bf16 v[52:55], v[88:91], a[20:23], v[52:55]
    s_waitcnt lgkmcnt(9)
    v_mfma_f32_16x16x32_bf16 v[32:35], a[28:31], v[92:95], v[32:35]
    ds_read_b128 v[88:91], v206 offset:0
    v_mfma_f32_16x16x32_bf16 v[52:55], v[92:95], a[32:35], v[52:55]
    s_waitcnt lgkmcnt(9)
    v_mfma_f32_16x16x32_bf16 v[32:35], a[40:43], v[96:99], v[32:35]
    ds_read_b128 v[92:95], v207 offset:0
    v_mfma_f32_16x16x32_bf16 v[52:55], v[96:99], a[44:47], v[52:55]
    s_waitcnt lgkmcnt(9)
    v_mfma_f32_16x16x32_bf16 v[32:35], a[52:55], v[100:103], v[32:35]
    ds_read_b128 v[96:99], v206 offset:10240
    v_mfma_f32_16x16x32_bf16 v[52:55], v[100:103], a[56:59], v[52:55]
    s_waitcnt lgkmcnt(9)
    v_mfma_f32_16x16x32_bf16 v[32:35], a[64:67], v[104:107], v[32:35]
    ds_read_b128 v[100:103], v207 offset:10240
    v_mfma_f32_16x16x32_bf16 v[52:55], v[104:107], a[68:71], v[52:55]
    s_waitcnt lgkmcnt(8)
    v_mfma_f32_16x16x32_bf16 v[32:35], a[76:79], v[108:111], v[32:35]
    ds_read_b128 v[104:107], v206 offset:20480
    v_mfma_f32_16x16x32_bf16 v[52:55], v[108:111], a[80:83], v[52:55]
    s_waitcnt lgkmcnt(5)
    v_mfma_f32_16x16x32_bf16 v[32:35], a[88:91], v[84:87], v[32:35]
    v_add_f32 v144, v144, v146
    v_add_f32 v145, v145, v147
    ds_read_b128 v[108:111], v207 offset:20480
    v_mfma_f32_16x16x32_bf16 v[52:55], v[84:87], a[92:95], v[52:55]
    v_add_f32 v148, v148, v150
    s_waitcnt lgkmcnt(5)
    v_mfma_f32_16x16x32_bf16 v[32:35], a[100:103], v[88:91], v[32:35]
    v_add_f32 v149, v149, v151
    v_add_f32 v144, v144, v148
    ds_read_b128 v[84:87], v206 offset:30720
    v_mfma_f32_16x16x32_bf16 v[52:55], v[88:91], a[104:107], v[52:55]
    v_add_f32 v145, v145, v149
    s_waitcnt lgkmcnt(5)
    v_mfma_f32_16x16x32_bf16 v[32:35], a[112:115], v[92:95], v[32:35]
    v_mul_f32 v156, 0x3b000000, v144
    v_mul_f32 v157, 0x3b000000, v145
    ds_read_b128 v[88:91], v207 offset:30720
    v_mfma_f32_16x16x32_bf16 v[52:55], v[92:95], a[116:119], v[52:55]
    v_fma_f32 v157, -v156, v156, v157
    s_waitcnt lgkmcnt(5)
    v_mfma_f32_16x16x32_bf16 v[32:35], a[124:127], v[96:99], v[32:35]
    v_max_f32 v157, 0, v157
    v_cvt_pk_bf16_f32 v156, v156, v157
    v_mfma_f32_16x16x32_bf16 v[52:55], v[96:99], a[128:131], v[52:55]
    v_and_b32 v157, 0xffff0000, v156
    s_waitcnt lgkmcnt(4)
    v_mfma_f32_16x16x32_bf16 v[32:35], a[136:139], v[100:103], v[32:35]
    v_lshlrev_b32 v156, 16, v156
    v_add_f32 v157, 0x3727c5ac, v157
    v_mfma_f32_16x16x32_bf16 v[52:55], v[100:103], a[140:143], v[52:55]
    v_cvt_pk_bf16_f32 v157, v157, v157
    s_waitcnt lgkmcnt(3)
    v_mfma_f32_16x16x32_bf16 v[32:35], a[148:151], v[104:107], v[32:35]
    v_lshlrev_b32 v157, 16, v157
    v_sqrt_f32 v157, v157
    v_mfma_f32_16x16x32_bf16 v[52:55], v[104:107], a[152:155], v[52:55]
    v_cvt_pk_bf16_f32 v157, v157, v157
    s_waitcnt lgkmcnt(2)
    v_mfma_f32_16x16x32_bf16 v[32:35], a[160:163], v[108:111], v[32:35]
    v_lshlrev_b32 v157, 16, v157
    v_rcp_f32 v154, v157
    v_mfma_f32_16x16x32_bf16 v[52:55], v[108:111], a[164:167], v[52:55]
    v_mul_f32 v155, -v156, v154
    s_waitcnt lgkmcnt(1)
    v_mfma_f32_16x16x32_bf16 v[32:35], a[172:175], v[84:87], v[32:35]
    s_mul_i32 s71, s3, 640
    s_add_u32 s71, s71, 92416
    v_mfma_f32_16x16x32_bf16 v[52:55], v[84:87], a[176:179], v[52:55]
    v_lshl_add_u32 v158, v2, 2, s71
    s_waitcnt lgkmcnt(0)
    v_mfma_f32_16x16x32_bf16 v[32:35], a[184:187], v[88:91], v[32:35]
    ds_write2_b32 v158, v154, v155 offset0:0 offset1:80
    v_mfma_f32_16x16x32_bf16 v[52:55], v[88:91], a[188:191], v[52:55]
    s_mul_i32 s61, s3, 640
    s_add_u32 s61, s61, 92416
    v_lshl_add_u32 v13, v1, 2, s61
    v_lshl_add_u32 v14, v2, 2, s61
    v_lshl_add_u32 v15, v3, 4, s61
    s_waitcnt lgkmcnt(0)
    ds_read2_b32 v[84:85], v14 offset0:0 offset1:80
    ds_read2_b32 v[86:87], v14 offset0:16 offset1:96
    ds_read2_b32 v[88:89], v14 offset0:32 offset1:112
    ds_read2_b32 v[90:91], v14 offset0:48 offset1:128
    ds_read2_b32 v[92:93], v14 offset0:64 offset1:144
    ds_read_b128 v[94:97], v15 offset:0
    ds_read_b128 v[98:101], v15 offset:320
    ds_read_b128 v[102:105], v15 offset:64
    ds_read_b128 v[106:109], v15 offset:384
    ds_read_b128 v[110:113], v15 offset:128
    ds_read_b128 v[114:117], v15 offset:448
    ds_read_b128 v[118:121], v15 offset:192
    ds_read_b128 v[122:125], v15 offset:512
    ds_read_b128 v[126:129], v15 offset:256
    ds_read_b128 v[130:133], v15 offset:576
    s_waitcnt lgkmcnt(10)
    v_pk_mul_f32 v[188:189], v[228:229], v[84:85] op_sel:[0,1] op_sel_hi:[1,1]
    v_pk_fma_f32 v[188:189], v[32:33], v[84:85], v[188:189] op_sel:[0,0,0] op_sel_hi:[1,0,1]
    v_pk_mul_f32 v[190:191], v[230:231], v[84:85] op_sel:[0,1] op_sel_hi:[1,1]
    v_pk_fma_f32 v[190:191], v[34:35], v[84:85], v[190:191] op_sel:[0,0,0] op_sel_hi:[1,0,1]
    v_cvt_pk_bf16_f32 v168, v188, v189
    v_cvt_pk_bf16_f32 v169, v190, v191
    v_pk_mul_f32 v[188:189], v[228:229], v[86:87] op_sel:[0,1] op_sel_hi:[1,1]
    v_pk_fma_f32 v[188:189], v[36:37], v[86:87], v[188:189] op_sel:[0,0,0] op_sel_hi:[1,0,1]
    v_pk_mul_f32 v[190:191], v[230:231], v[86:87] op_sel:[0,1] op_sel_hi:[1,1]
    v_pk_fma_f32 v[190:191], v[38:39], v[86:87], v[190:191] op_sel:[0,0,0] op_sel_hi:[1,0,1]
    v_cvt_pk_bf16_f32 v170, v188, v189
    v_cvt_pk_bf16_f32 v171, v190, v191
    v_pk_mul_f32 v[188:189], v[224:225], v[86:87] op_sel:[0,1] op_sel_hi:[1,1]
    v_pk_fma_f32 v[188:189], v[16:17], v[86:87], v[188:189] op_sel:[0,0,0] op_sel_hi:[1,0,1]
    v_pk_mul_f32 v[190:191], v[226:227], v[86:87] op_sel:[0,1] op_sel_hi:[1,1]
    v_pk_fma_f32 v[190:191], v[18:19], v[86:87], v[190:191] op_sel:[0,0,0] op_sel_hi:[1,0,1]
    v_cvt_pk_bf16_f32 v160, v188, v189
    v_cvt_pk_bf16_f32 v161, v190, v191
    v_pk_mul_f32 v[188:189], v[228:229], v[88:89] op_sel:[0,1] op_sel_hi:[1,1]
    v_pk_fma_f32 v[188:189], v[40:41], v[88:89], v[188:189] op_sel:[0,0,0] op_sel_hi:[1,0,1]
    v_pk_mul_f32 v[190:191], v[230:231], v[88:89] op_sel:[0,1] op_sel_hi:[1,1]
    v_pk_fma_f32 v[190:191], v[42:43], v[88:89], v[190:191] op_sel:[0,0,0] op_sel_hi:[1,0,1]
    v_cvt_pk_bf16_f32 v172, v188, v189
    v_cvt_pk_bf16_f32 v173, v190, v191
    v_pk_mul_f32 v[188:189], v[224:225], v[88:89] op_sel:[0,1] op_sel_hi:[1,1]
    v_pk_fma_f32 v[188:189], v[20:21], v[88:89], v[188:189] op_sel:[0,0,0] op_sel_hi:[1,0,1]
    v_pk_mul_f32 v[190:191], v[226:227], v[88:89] op_sel:[0,1] op_sel_hi:[1,1]
    v_pk_fma_f32 v[190:191], v[22:23], v[88:89], v[190:191] op_sel:[0,0,0] op_sel_hi:[1,0,1]
    v_cvt_pk_bf16_f32 v162, v188, v189
    v_cvt_pk_bf16_f32 v163, v190, v191
    v_pk_mul_f32 v[188:189], v[228:229], v[90:91] op_sel:[0,1] op_sel_hi:[1,1]
    v_pk_fma_f32 v[188:189], v[44:45], v[90:91], v[188:189] op_sel:[0,0,0] op_sel_hi:[1,0,1]
    v_pk_mul_f32 v[190:191], v[230:231], v[90:91] op_sel:[0,1] op_sel_hi:[1,1]
    v_pk_fma_f32 v[190:191], v[46:47], v[90:91], v[190:191] op_sel:[0,0,0] op_sel_hi:[1,0,1]
    v_cvt_pk_bf16_f32 v174, v188, v189
    v_cvt_pk_bf16_f32 v175, v190, v191
    v_pk_mul_f32 v[188:189], v[224:225], v[90:91] op_sel:[0,1] op_sel_hi:[1,1]
    v_pk_fma_f32 v[188:189], v[24:25], v[90:91], v[188:189] op_sel:[0,0,0] op_sel_hi:[1,0,1]
    v_pk_mul_f32 v[190:191], v[226:227], v[90:91] op_sel:[0,1] op_sel_hi:[1,1]
    v_pk_fma_f32 v[190:191], v[26:27], v[90:91], v[190:191] op_sel:[0,0,0] op_sel_hi:[1,0,1]
    v_cvt_pk_bf16_f32 v164, v188, v189
    v_cvt_pk_bf16_f32 v165, v190, v191
    v_pk_mul_f32 v[188:189], v[228:229], v[92:93] op_sel:[0,1] op_sel_hi:[1,1]
    v_pk_fma_f32 v[188:189], v[48:49], v[92:93], v[188:189] op_sel:[0,0,0] op_sel_hi:[1,0,1]
    v_pk_mul_f32 v[190:191], v[230:231], v[92:93] op_sel:[0,1] op_sel_hi:[1,1]
    v_pk_fma_f32 v[190:191], v[50:51], v[92:93], v[190:191] op_sel:[0,0,0] op_sel_hi:[1,0,1]
    v_cvt_pk_bf16_f32 v176, v188, v189
    v_cvt_pk_bf16_f32 v177, v190, v191
    v_pk_mul_f32 v[188:189], v[224:225], v[92:93] op_sel:[0,1] op_sel_hi:[1,1]
    v_pk_fma_f32 v[188:189], v[28:29], v[92:93], v[188:189] op_sel:[0,0,0] op_sel_hi:[1,0,1]
    v_pk_mul_f32 v[190:191], v[226:227], v[92:93] op_sel:[0,1] op_sel_hi:[1,1]
    v_pk_fma_f32 v[190:191], v[30:31], v[92:93], v[190:191] op_sel:[0,0,0] op_sel_hi:[1,0,1]
    v_cvt_pk_bf16_f32 v166, v188, v189
    v_cvt_pk_bf16_f32 v167, v190, v191
    v_mfma_f32_16x16x16_bf16 v[16:19], v[170:171], v[160:161], 0
    v_mfma_f32_16x16x16_bf16 v[32:35], v[168:169], v[160:161], 0
    v_mfma_f32_16x16x16_bf16 v[20:23], v[172:173], v[162:163], 0
    v_mfma_f32_16x16x16_bf16 v[36:39], v[170:171], v[162:163], 0
    v_mfma_f32_16x16x16_bf16 v[24:27], v[174:175], v[164:165], 0
    v_mfma_f32_16x16x16_bf16 v[40:43], v[172:173], v[164:165], 0
    v_mfma_f32_16x16x16_bf16 v[28:31], v[176:177], v[166:167], 0
    v_mfma_f32_16x16x16_bf16 v[44:47], v[174:175], v[166:167], 0
    s_waitcnt lgkmcnt(0)
    v_pk_mul_f32 v[192:193], v[98:99], v[232:233] op_sel:[0,0] op_sel_hi:[1,0]
    v_pk_fma_f32 v[192:193], v[52:53], v[94:95], v[192:193]
    v_pk_mul_f32 v[194:195], v[100:101], v[232:233] op_sel:[0,0] op_sel_hi:[1,0]
    v_pk_fma_f32 v[194:195], v[54:55], v[96:97], v[194:195]
    v_cvt_pk_bf16_f32 v178, v192, v193
    v_cvt_pk_bf16_f32 v179, v194, v195
    v_pk_mul_f32 v[192:193], v[106:107], v[232:233] op_sel:[0,0] op_sel_hi:[1,0]
    v_pk_fma_f32 v[192:193], v[56:57], v[102:103], v[192:193]
    v_pk_mul_f32 v[194:195], v[108:109], v[232:233] op_sel:[0,0] op_sel_hi:[1,0]
    v_pk_fma_f32 v[194:195], v[58:59], v[104:105], v[194:195]
    v_cvt_pk_bf16_f32 v180, v192, v193
    v_cvt_pk_bf16_f32 v181, v194, v195
    v_pk_mul_f32 v[192:193], v[114:115], v[232:233] op_sel:[0,0] op_sel_hi:[1,0]
    v_pk_fma_f32 v[192:193], v[60:61], v[110:111], v[192:193]
    v_pk_mul_f32 v[194:195], v[116:117], v[232:233] op_sel:[0,0] op_sel_hi:[1,0]
    v_pk_fma_f32 v[194:195], v[62:63], v[112:113], v[194:195]
    v_cvt_pk_bf16_f32 v182, v192, v193
    v_cvt_pk_bf16_f32 v183, v194, v195
    v_pk_mul_f32 v[192:193], v[122:123], v[232:233] op_sel:[0,0] op_sel_hi:[1,0]
    v_pk_fma_f32 v[192:193], v[64:65], v[118:119], v[192:193]
    v_pk_mul_f32 v[194:195], v[124:125], v[232:233] op_sel:[0,0] op_sel_hi:[1,0]
    v_pk_fma_f32 v[194:195], v[66:67], v[120:121], v[194:195]
    v_cvt_pk_bf16_f32 v184, v192, v193
    v_cvt_pk_bf16_f32 v185, v194, v195
    v_pk_mul_f32 v[192:193], v[130:131], v[232:233] op_sel:[0,0] op_sel_hi:[1,0]
    v_pk_fma_f32 v[192:193], v[68:69], v[126:127], v[192:193]
    v_pk_mul_f32 v[194:195], v[132:133], v[232:233] op_sel:[0,0] op_sel_hi:[1,0]
    v_pk_fma_f32 v[194:195], v[70:71], v[128:129], v[194:195]
    v_cvt_pk_bf16_f32 v186, v192, v193
    v_cvt_pk_bf16_f32 v187, v194, v195
    s_cmp_lg_u32 s4, 0
    s_cbranch_scc1 L_nomask_31
    s_nop 1
    v_mov_b32 v32, 0xf149f2ca
    v_mov_b32 v33, 0xf149f2ca
    v_mov_b32 v34, 0xf149f2ca
    v_mov_b32 v35, 0xf149f2ca
    s_nop 2
L_nomask_31:
    v_cndmask_b32 v16, v16, v17, s[54:55]
    v_cndmask_b32 v32, v32, v33, s[54:55]
    v_cndmask_b32 v48, v32, v16, s[56:57]
    v_cndmask_b32 v18, v18, v19, s[54:55]
    v_cndmask_b32 v34, v34, v35, s[54:55]
    v_cndmask_b32 v49, v34, v18, s[58:59]
    v_cvt_pk_bf16_f32 v49, v48, v49
    v_lshlrev_b32 v48, 16, v49
    v_and_b32 v49, 0xffff0000, v49
    v_max_f32 v56, v48, v49
    v_cndmask_b32 v20, v20, v21, s[54:55]
    v_cndmask_b32 v36, v36, v37, s[54:55]
    v_cndmask_b32 v50, v36, v20, s[56:57]
    v_cndmask_b32 v22, v22, v23, s[54:55]
    v_cndmask_b32 v38, v38, v39, s[54:55]
    v_cndmask_b32 v51, v38, v22, s[58:59]
    v_cvt_pk_bf16_f32 v51, v50, v51
    v_lshlrev_b32 v50, 16, v51
    v_and_b32 v51, 0xffff0000, v51
    v_max_f32 v57, v50, v51
    v_cndmask_b32 v24, v24, v25, s[54:55]
    v_cndmask_b32 v40, v40, v41, s[54:55]
    v_cndmask_b32 v52, v40, v24, s[56:57]
    v_cndmask_b32 v26, v26, v27, s[54:55]
    v_cndmask_b32 v42, v42, v43, s[54:55]
    v_cndmask_b32 v53, v42, v26, s[58:59]
    v_cvt_pk_bf16_f32 v53, v52, v53
    v_lshlrev_b32 v52, 16, v53
    v_and_b32 v53, 0xffff0000, v53
    v_max_f32 v58, v52, v53
    v_cndmask_b32 v28, v28, v29, s[54:55]
    v_cndmask_b32 v44, v44, v45, s[54:55]
    v_cndmask_b32 v54, v44, v28, s[56:57]
    v_cndmask_b32 v30, v30, v31, s[54:55]
    v_cndmask_b32 v46, v46, v47, s[54:55]
    v_cndmask_b32 v55, v46, v30, s[58:59]
    v_cvt_pk_bf16_f32 v55, v54, v55
    v_lshlrev_b32 v54, 16, v55
    v_and_b32 v55, 0xffff0000, v55
    v_max_f32 v59, v54, v55
    v_mov_b32 v60, v56
    v_mov_b32 v61, v57
    v_mov_b32 v62, v58
    v_mov_b32 v63, v59
    v_permlane16_swap_b32 v56, v60
    v_permlane16_swap_b32 v57, v61
    v_permlane16_swap_b32 v58, v62
    v_permlane16_swap_b32 v59, v63
    v_max_f32 v56, v56, v60
    v_max_f32 v57, v57, v61
    v_max_f32 v58, v58, v62
    v_max_f32 v59, v59, v63
    v_mov_b32 v60, v56
    v_mov_b32 v61, v57
    v_mov_b32 v62, v58
    v_mov_b32 v63, v59
    v_permlane32_swap_b32 v56, v60
    v_permlane32_swap_b32 v57, v61
    v_permlane32_swap_b32 v58, v62
    v_permlane32_swap_b32 v59, v63
    v_max_f32 v56, v56, v60
    v_max_f32 v57, v57, v61
    v_max_f32 v58, v58, v62
    v_max_f32 v59, v59, v63
    s_mov_b32 s61, 0x3eb8aa3b
    v_sub_f32 v48, v48, v56
    v_sub_f32 v49, v49, v56
    v_sub_f32 v50, v50, v57
    v_sub_f32 v51, v51, v57
    v_sub_f32 v52, v52, v58
    v_sub_f32 v53, v53, v58
    v_sub_f32 v54, v54, v59
    v_sub_f32 v55, v55, v59
    v_mul_f32 v48, s61, v48
    v_mul_f32 v49, s61, v49
    v_mul_f32 v50, s61, v50
    v_mul_f32 v51, s61, v51
    v_mul_f32 v52, s61, v52
    v_mul_f32 v53, s61, v53
    v_mul_f32 v54, s61, v54
    v_mul_f32 v55, s61, v55
    v_exp_f32 v48, v48
    v_exp_f32 v49, v49
    v_exp_f32 v50, v50
    v_exp_f32 v51, v51
    v_exp_f32 v52, v52
    v_exp_f32 v53, v53
    v_exp_f32 v54, v54
    v_exp_f32 v55, v55
    v_add_f32 v56, v48, v49
    v_add_f32 v57, v50, v51
    v_add_f32 v58, v52, v53
    v_add_f32 v59, v54, v55
    v_mov_b32 v60, v56
    v_mov_b32 v61, v57
    v_mov_b32 v62, v58
    v_mov_b32 v63, v59
    v_permlane16_swap_b32 v56, v60
    v_permlane16_swap_b32 v57, v61
    v_permlane16_swap_b32 v58, v62
    v_permlane16_swap_b32 v59, v63
    v_add_f32 v56, v56, v60
    v_add_f32 v57, v57, v61
    v_add_f32 v58, v58, v62
    v_add_f32 v59, v59, v63
    v_mov_b32 v60, v56
    v_mov_b32 v61, v57
    v_mov_b32 v62, v58
    v_mov_b32 v63, v59
    v_permlane32_swap_b32 v56, v60
    v_permlane32_swap_b32 v57, v61
    v_permlane32_swap_b32 v58, v62
    v_permlane32_swap_b32 v59, v63
    v_add_f32 v56, v56, v60
    v_add_f32 v57, v57, v61
    v_add_f32 v58, v58, v62
    v_add_f32 v59, v59, v63
    v_rcp_f32 v56, v56
    v_rcp_f32 v57, v57
    v_rcp_f32 v58, v58
    v_rcp_f32 v59, v59
    v_cndmask_b32 v60, v56, 0, s[54:55]
    v_cndmask_b32 v61, 0, v56, s[54:55]
    v_mul_f32 v62, v48, v60
    v_mul_f32 v63, v48, v61
    v_cvt_pk_bf16_f32 v62, v62, v63
    v_cndmask_b32 v16, 0, v62, s[56:57]
    v_cndmask_b32 v24, v62, 0, s[56:57]
    v_mul_f32 v62, v49, v60
    v_mul_f32 v63, v49, v61
    v_cvt_pk_bf16_f32 v62, v62, v63
    v_cndmask_b32 v17, 0, v62, s[58:59]
    v_cndmask_b32 v25, v62, 0, s[58:59]
    v_cndmask_b32 v60, v57, 0, s[54:55]
    v_cndmask_b32 v61, 0, v57, s[54:55]
    v_mul_f32 v62, v50, v60
    v_mul_f32 v63, v50, v61
    v_cvt_pk_bf16_f32 v62, v62, v63
    v_cndmask_b32 v18, 0, v62, s[56:57]
    v_cndmask_b32 v26, v62, 0, s[56:57]
    v_mul_f32 v62, v51, v60
    v_mul_f32 v63, v51, v61
    v_cvt_pk_bf16_f32 v62, v62, v63
    v_cndmask_b32 v19, 0, v62, s[58:59]
    v_cndmask_b32 v27, v62, 0, s[58:59]
    v_cndmask_b32 v60, v58, 0, s[54:55]
    v_cndmask_b32 v61, 0, v58, s[54:55]
    v_mul_f32 v62, v52, v60
    v_mul_f32 v63, v52, v61
    v_cvt_pk_bf16_f32 v62, v62, v63
    v_cndmask_b32 v20, 0, v62, s[56:57]
    v_cndmask_b32 v28, v62, 0, s[56:57]
    v_mul_f32 v62, v53, v60
    v_mul_f32 v63, v53, v61
    v_cvt_pk_bf16_f32 v62, v62, v63
    v_cndmask_b32 v21, 0, v62, s[58:59]
    v_cndmask_b32 v29, v62, 0, s[58:59]
    v_cndmask_b32 v60, v59, 0, s[54:55]
    v_cndmask_b32 v61, 0, v59, s[54:55]
    v_mul_f32 v62, v54, v60
    v_mul_f32 v63, v54, v61
    v_cvt_pk_bf16_f32 v62, v62, v63
    v_cndmask_b32 v22, 0, v62, s[56:57]
    v_cndmask_b32 v30, v62, 0, s[56:57]
    v_mul_f32 v62, v55, v60
    v_mul_f32 v63, v55, v61
    v_cvt_pk_bf16_f32 v62, v62, v63
    v_cndmask_b32 v23, 0, v62, s[58:59]
    v_cndmask_b32 v31, v62, 0, s[58:59]
    v_mfma_f32_16x16x16_bf16 v[32:35], v[180:181], v[16:17], 0
    v_mfma_f32_16x16x16_bf16 v[36:39], v[182:183], v[18:19], 0
    v_mfma_f32_16x16x16_bf16 v[40:43], v[184:185], v[20:21], 0
    v_mfma_f32_16x16x16_bf16 v[44:47], v[186:187], v[22:23], 0
    v_mfma_f32_16x16x16_bf16 v[32:35], v[178:179], v[24:25], v[32:35]
    v_mfma_f32_16x16x16_bf16 v[36:39], v[180:181], v[26:27], v[36:39]
    v_mfma_f32_16x16x16_bf16 v[40:43], v[182:183], v[28:29], v[40:43]
    v_mfma_f32_16x16x16_bf16 v[44:47], v[184:185], v[30:31], v[44:47]
    s_nop 4
    v_cvt_pk_bf16_f32 v48, v32, v33
    v_cvt_pk_bf16_f32 v49, v34, v35
    v_cvt_pk_bf16_f32 v50, v36, v37
    v_cvt_pk_bf16_f32 v51, v38, v39
    v_cvt_pk_bf16_f32 v52, v40, v41
    v_cvt_pk_bf16_f32 v53, v42, v43
    v_cvt_pk_bf16_f32 v54, v44, v45
    v_cvt_pk_bf16_f32 v55, v46, v47
    v_lshrrev_b32 v13, 1, v3
    s_lshl_b32 s61, s3, 1
    v_add_u32 v13, s61, v13
    v_and_b32 v14, 7, v2
    v_xor_b32 v13, v13, v14
    v_lshlrev_b32 v13, 4, v13
    v_lshl_add_u32 v13, v2, 7, v13
    v_and_b32 v14, 1, v3
    v_lshl_add_u32 v13, v14, 3, v13
    v_add_u32 v13, 82944, v13
    ds_write_b64 v13, v[48:49] offset:0
    ds_write_b64 v13, v[50:51] offset:2048
    ds_write_b64 v13, v[52:53] offset:4096
    ds_write_b64 v13, v[54:55] offset:6144
    v_lshlrev_b32 v14, 4, v0
    v_add_u32 v14, 82944, v14
    v_lshrrev_b32 v15, 3, v0
    v_xor_b32 v13, v0, v15
    v_and_b32 v13, 7, v13
    v_lshlrev_b32 v13, 4, v13
    v_lshl_add_u32 v13, v15, 10, v13
    s_waitcnt lgkmcnt(0)
    s_barrier
    ds_read_b128 v[56:59], v14 offset:0
    ds_read_b128 v[60:63], v14 offset:4096
    s_waitcnt lgkmcnt(0)
    s_add_u32 s61, s69, 8388608
    s_add_u32 s62, s61, 32768
    s_cmp_lg_u32 s74, 0
    s_cbranch_scc1 L_sp_32
    buffer_store_dwordx4 v[56:59], v13, s[40:43], s61 offen sc1
    buffer_store_dwordx4 v[60:63], v13, s[40:43], s62 offen sc1
    s_branch L_se_33
L_sp_32:
    buffer_store_dwordx4 v[56:59], v13, s[40:43], s61 offen
    buffer_store_dwordx4 v[60:63], v13, s[40:43], s62 offen
L_se_33:
    v_add_u32 v120, 98304, v141
    v_xor_b32 v121, 64, v120
    s_waitcnt vmcnt(0)
    s_barrier
    s_cmp_lg_u32 s3, 0
    s_cbranch_scc1 L_sig_34
    s_lshl_b32 s61, s4, 3
    v_add_u32 v14, s61, v1
    v_lshlrev_b32 v14, 15, v14
    s_lshl_b32 s61, s5, 7
    s_add_u32 s61, s61, 16801824
    v_add_u32 v14, s61, v14
    v_mov_b32 v222, s78
    v_mov_b32 v223, s79
    s_mov_b32 exec_lo, 0xff
    s_mov_b32 exec_hi, 0
    s_cmp_lg_u32 s74, 0
    s_cbranch_scc1 L_sp_35
    buffer_store_dwordx2 v[222:223], v14, s[40:43], 0 offen sc1
    s_branch L_se_36
L_sp_35:
    buffer_store_dwordx2 v[222:223], v14, s[40:43], 0 offen
L_se_36:
    s_mov_b64 exec, -1
    s_nop 1
L_sig_34:
    s_mov_b32 exec_lo, 0xff
    s_mov_b32 exec_hi, 0
    s_add_u32 s61, s68, 24608
    s_nop 1
L_poll_o3_37:
    buffer_load_dwordx2 v[222:223], v142, s[40:43], s61 offen sc1
    s_waitcnt vmcnt(0)
    v_cmp_ne_u64 vcc, s[78:79], v[222:223]
    s_cbranch_vccnz L_poll_o3_37
    s_mov_b64 exec, -1
    s_lshl_b32 s80, s6, 6
    v_add_u32 v212, s66, v143
    v_xor_b32 v213, 64, v212
    v_add_u32 v213, 8192, v213
    s_lshl_b32 s70, s3, 11
    s_add_u32 s71, s80, 8388608
    s_add_u32 m0, s70, 98304
    s_nop 0
    buffer_load_dwordx4 v212, s[40:43], s71 offen sc1 lds
    s_add_u32 m0, s70, 99328
    s_nop 0
    buffer_load_dwordx4 v213, s[40:43], s71 offen sc1 lds
    s_add_u32 s80, s80, 128
    s_and_b32 s80, s80, 1023
    s_add_u32 s71, s80, 8388608
    s_add_u32 m0, s70, 106496
    s_nop 0
    buffer_load_dwordx4 v212, s[40:43], s71 offen sc1 lds
    s_add_u32 m0, s70, 107520
    s_nop 0
    buffer_load_dwordx4 v213, s[40:43], s71 offen sc1 lds
    s_add_u32 s80, s80, 128
    s_and_b32 s80, s80, 1023
    s_add_u32 s71, s80, 8388608
    s_add_u32 m0, s70, 114688
    s_nop 0
    buffer_load_dwordx4 v212, s[40:43], s71 offen sc1 lds
    s_add_u32 m0, s70, 115712
    s_nop 0
    buffer_load_dwordx4 v213, s[40:43], s71 offen sc1 lds
    s_add_u32 s80, s80, 128
    s_and_b32 s80, s80, 1023
    s_add_u32 s71, s80, 8388608
    s_add_u32 m0, s70, 122880
    s_nop 0
    buffer_load_dwordx4 v212, s[40:43], s71 offen sc1 lds
    s_add_u32 m0, s70, 123904
    s_nop 0
    buffer_load_dwordx4 v213, s[40:43], s71 offen sc1 lds
    s_add_u32 s80, s80, 128
    s_and_b32 s80, s80, 1023
    s_waitcnt vmcnt(4)
    s_barrier
    ds_read_b128 v[32:35], v120 offset:0
    ds_read_b128 v[36:39], v120 offset:2048
    ds_read_b128 v[40:43], v120 offset:4096
    ds_read_b128 v[44:47], v120 offset:6144
    ds_read_b128 v[48:51], v121 offset:0
    ds_read_b128 v[52:55], v121 offset:2048
    ds_read_b128 v[56:59], v121 offset:4096
    ds_read_b128 v[60:63], v121 offset:6144
    s_waitcnt lgkmcnt(4)
    v_mfma_f32_16x16x32_bf16 v[16:19], a[192:195], v[32:35], 0
    s_add_u32 s71, s80, 8388608
    s_add_u32 m0, s70, 131072
    ds_read_b128 v[144:147], v120 offset:8192
    v_mfma_f32_16x16x32_bf16 v[20:23], a[192:195], v[36:39], 0
    buffer_load_dwordx4 v212, s[40:43], s71 offen sc1 lds
    s_add_u32 m0, s70, 132096
    ds_read_b128 v[148:151], v120 offset:10240
    v_mfma_f32_16x16x32_bf16 v[24:27], a[192:195], v[40:43], 0
    buffer_load_dwordx4 v213, s[40:43], s71 offen sc1 lds
    s_add_u32 s80, s80, 128
    ds_read_b128 v[152:155], v120 offset:12288
    v_mfma_f32_16x16x32_bf16 v[28:31], a[192:195], v[44:47], 0
    s_and_b32 s80, s80, 1023
    ds_read_b128 v[156:159], v120 offset:14336
    s_waitcnt lgkmcnt(4)
    v_mfma_f32_16x16x32_bf16 v[16:19], a[196:199], v[48:51], v[16:19]
    s_add_u32 s71, s80, 8388608
    s_add_u32 m0, s70, 139264
    ds_read_b128 v[32:35], v121 offset:8192
    v_mfma_f32_16x16x32_bf16 v[20:23], a[196:199], v[52:55], v[20:23]
    buffer_load_dwordx4 v212, s[40:43], s71 offen sc1 lds
    s_add_u32 m0, s70, 140288
    ds_read_b128 v[36:39], v121 offset:10240
    v_mfma_f32_16x16x32_bf16 v[24:27], a[196:199], v[56:59], v[24:27]
    buffer_load_dwordx4 v213, s[40:43], s71 offen sc1 lds
    s_add_u32 s80, s80, 128
    ds_read_b128 v[40:43], v121 offset:12288
    v_mfma_f32_16x16x32_bf16 v[28:31], a[196:199], v[60:63], v[28:31]
    s_and_b32 s80, s80, 1023
    ds_read_b128 v[44:47], v121 offset:14336
    s_waitcnt vmcnt(4)
    s_barrier
    s_waitcnt lgkmcnt(4)
    v_mfma_f32_16x16x32_bf16 v[16:19], a[200:203], v[144:147], v[16:19]
    s_add_u32 s71, s80, 8388608
    s_add_u32 m0, s70, 147456
    ds_read_b128 v[48:51], v120 offset:16384
    v_mfma_f32_16x16x32_bf16 v[20:23], a[200:203], v[148:151], v[20:23]
    buffer_load_dwordx4 v212, s[40:43], s71 offen sc1 lds
    s_add_u32 m0, s70, 148480
    ds_read_b128 v[52:55], v120 offset:18432
    v_mfma_f32_16x16x32_bf16 v[24:27], a[200:203], v[152:155], v[24:27]
    buffer_load_dwordx4 v213, s[40:43], s71 offen sc1 lds
    s_add_u32 s80, s80, 128
    ds_read_b128 v[56:59], v120 offset:20480
    v_mfma_f32_16x16x32_bf16 v[28:31], a[200:203], v[156:159], v[28:31]
    s_and_b32 s80, s80, 1023
    ds_read_b128 v[60:63], v120 offset:22528
    s_waitcnt lgkmcnt(4)
    v_mfma_f32_16x16x32_bf16 v[16:19], a[204:207], v[32:35], v[16:19]
    s_add_u32 s71, s80, 8388608
    s_add_u32 m0, s70, 155648
    ds_read_b128 v[144:147], v121 offset:16384
    v_mfma_f32_16x16x32_bf16 v[20:23], a[204:207], v[36:39], v[20:23]
    buffer_load_dwordx4 v212, s[40:43], s71 offen sc1 lds
    s_add_u32 m0, s70, 156672
    ds_read_b128 v[148:151], v121 offset:18432
    v_mfma_f32_16x16x32_bf16 v[24:27], a[204:207], v[40:43], v[24:27]
    buffer_load_dwordx4 v213, s[40:43], s71 offen sc1 lds
    s_add_u32 s80, s80, 128
    ds_read_b128 v[152:155], v121 offset:20480
    v_mfma_f32_16x16x32_bf16 v[28:31], a[204:207], v[44:47], v[28:31]
    s_and_b32 s80, s80, 1023
    ds_read_b128 v[156:159], v121 offset:22528
    s_waitcnt lgkmcnt(4)
    v_mfma_f32_16x16x32_bf16 v[16:19], a[208:211], v[48:51], v[16:19]
    ds_read_b128 v[32:35], v120 offset:24576
    v_mfma_f32_16x16x32_bf16 v[20:23], a[208:211], v[52:55], v[20:23]
    ds_read_b128 v[36:39], v120 offset:26624
    v_mfma_f32_16x16x32_bf16 v[24:27], a[208:211], v[56:59], v[24:27]
    ds_read_b128 v[40:43], v120 offset:28672
    v_mfma_f32_16x16x32_bf16 v[28:31], a[208:211], v[60:63], v[28:31]
    ds_read_b128 v[44:47], v120 offset:30720
    s_waitcnt lgkmcnt(4)
    v_mfma_f32_16x16x32_bf16 v[16:19], a[212:215], v[144:147], v[16:19]
    ds_read_b128 v[48:51], v121 offset:24576
    v_mfma_f32_16x16x32_bf16 v[20:23], a[212:215], v[148:151], v[20:23]
    ds_read_b128 v[52:55], v121 offset:26624
    v_mfma_f32_16x16x32_bf16 v[24:27], a[212:215], v[152:155], v[24:27]
    ds_read_b128 v[56:59], v121 offset:28672
    v_mfma_f32_16x16x32_bf16 v[28:31], a[212:215], v[156:159], v[28:31]
    ds_read_b128 v[60:63], v121 offset:30720
    s_waitcnt vmcnt(4)
    s_barrier
    s_waitcnt lgkmcnt(4)
    v_mfma_f32_16x16x32_bf16 v[16:19], a[216:219], v[32:35], v[16:19]
    ds_read_b128 v[144:147], v120 offset:32768
    v_mfma_f32_16x16x32_bf16 v[20:23], a[216:219], v[36:39], v[20:23]
    ds_read_b128 v[148:151], v120 offset:34816
    v_mfma_f32_16x16x32_bf16 v[24:27], a[216:219], v[40:43], v[24:27]
    ds_read_b128 v[152:155], v120 offset:36864
    v_mfma_f32_16x16x32_bf16 v[28:31], a[216:219], v[44:47], v[28:31]
    ds_read_b128 v[156:159], v120 offset:38912
    s_waitcnt lgkmcnt(4)
    v_mfma_f32_16x16x32_bf16 v[16:19], a[220:223], v[48:51], v[16:19]
    ds_read_b128 v[32:35], v121 offset:32768
    v_mfma_f32_16x16x32_bf16 v[20:23], a[220:223], v[52:55], v[20:23]
    ds_read_b128 v[36:39], v121 offset:34816
    v_mfma_f32_16x16x32_bf16 v[24:27], a[220:223], v[56:59], v[24:27]
    ds_read_b128 v[40:43], v121 offset:36864
    v_mfma_f32_16x16x32_bf16 v[28:31], a[220:223], v[60:63], v[28:31]
    ds_read_b128 v[44:47], v121 offset:38912
    s_waitcnt lgkmcnt(4)
    v_mfma_f32_16x16x32_bf16 v[16:19], a[224:227], v[144:147], v[16:19]
    ds_read_b128 v[48:51], v120 offset:40960
    v_mfma_f32_16x16x32_bf16 v[20:23], a[224:227], v[148:151], v[20:23]
    ds_read_b128 v[52:55], v120 offset:43008
    v_mfma_f32_16x16x32_bf16 v[24:27], a[224:227], v[152:155], v[24:27]
    ds_read_b128 v[56:59], v120 offset:45056
    v_mfma_f32_16x16x32_bf16 v[28:31], a[224:227], v[156:159], v[28:31]
    ds_read_b128 v[60:63], v120 offset:47104
    s_waitcnt lgkmcnt(4)
    v_mfma_f32_16x16x32_bf16 v[16:19], a[228:231], v[32:35], v[16:19]
    ds_read_b128 v[144:147], v121 offset:40960
    v_mfma_f32_16x16x32_bf16 v[20:23], a[228:231], v[36:39], v[20:23]
    ds_read_b128 v[148:151], v121 offset:43008
    v_mfma_f32_16x16x32_bf16 v[24:27], a[228:231], v[40:43], v[24:27]
    ds_read_b128 v[152:155], v121 offset:45056
    v_mfma_f32_16x16x32_bf16 v[28:31], a[228:231], v[44:47], v[28:31]
    ds_read_b128 v[156:159], v121 offset:47104
    s_waitcnt vmcnt(0)
    s_barrier
    s_waitcnt lgkmcnt(4)
    v_mfma_f32_16x16x32_bf16 v[16:19], a[232:235], v[48:51], v[16:19]
    ds_read_b128 v[32:35], v120 offset:49152
    v_mfma_f32_16x16x32_bf16 v[20:23], a[232:235], v[52:55], v[20:23]
    ds_read_b128 v[36:39], v120 offset:51200
    v_mfma_f32_16x16x32_bf16 v[24:27], a[232:235], v[56:59], v[24:27]
    ds_read_b128 v[40:43], v120 offset:53248
    v_mfma_f32_16x16x32_bf16 v[28:31], a[232:235], v[60:63], v[28:31]
    ds_read_b128 v[44:47], v120 offset:55296
    s_waitcnt lgkmcnt(4)
    v_mfma_f32_16x16x32_bf16 v[16:19], a[236:239], v[144:147], v[16:19]
    ds_read_b128 v[48:51], v121 offset:49152
    v_mfma_f32_16x16x32_bf16 v[20:23], a[236:239], v[148:151], v[20:23]
    ds_read_b128 v[52:55], v121 offset:51200
    v_mfma_f32_16x16x32_bf16 v[24:27], a[236:239], v[152:155], v[24:27]
    ds_read_b128 v[56:59], v121 offset:53248
    v_mfma_f32_16x16x32_bf16 v[28:31], a[236:239], v[156:159], v[28:31]
    ds_read_b128 v[60:63], v121 offset:55296
    s_waitcnt lgkmcnt(4)
    v_mfma_f32_16x16x32_bf16 v[16:19], a[240:243], v[32:35], v[16:19]
    ds_read_b128 v[144:147], v120 offset:57344
    v_mfma_f32_16x16x32_bf16 v[20:23], a[240:243], v[36:39], v[20:23]
    ds_read_b128 v[148:151], v120 offset:59392
    v_mfma_f32_16x16x32_bf16 v[24:27], a[240:243], v[40:43], v[24:27]
    ds_read_b128 v[152:155], v120 offset:61440
    v_mfma_f32_16x16x32_bf16 v[28:31], a[240:243], v[44:47], v[28:31]
    ds_read_b128 v[156:159], v120 offset:63488
    s_waitcnt lgkmcnt(4)
    v_mfma_f32_16x16x32_bf16 v[16:19], a[244:247], v[48:51], v[16:19]
    ds_read_b128 v[32:35], v121 offset:57344
    v_mfma_f32_16x16x32_bf16 v[20:23], a[244:247], v[52:55], v[20:23]
    ds_read_b128 v[36:39], v121 offset:59392
    v_mfma_f32_16x16x32_bf16 v[24:27], a[244:247], v[56:59], v[24:27]
    ds_read_b128 v[40:43], v121 offset:61440
    v_mfma_f32_16x16x32_bf16 v[28:31], a[244:247], v[60:63], v[28:31]
    ds_read_b128 v[44:47], v121 offset:63488
    s_waitcnt lgkmcnt(4)
    v_mfma_f32_16x16x32_bf16 v[16:19], a[248:251], v[144:147], v[16:19]
    v_mfma_f32_16x16x32_bf16 v[20:23], a[248:251], v[148:151], v[20:23]
    v_mfma_f32_16x16x32_bf16 v[24:27], a[248:251], v[152:155], v[24:27]
    v_mfma_f32_16x16x32_bf16 v[28:31], a[248:251], v[156:159], v[28:31]
    s_waitcnt lgkmcnt(0)
    v_mfma_f32_16x16x32_bf16 v[16:19], a[252:255], v[32:35], v[16:19]
    v_mfma_f32_16x16x32_bf16 v[20:23], a[252:255], v[36:39], v[20:23]
    v_mfma_f32_16x16x32_bf16 v[24:27], a[252:255], v[40:43], v[24:27]
    v_mfma_f32_16x16x32_bf16 v[28:31], a[252:255], v[44:47], v[28:31]
    s_nop 4
    v_cvt_pk_bf16_f32 v16, v16, v17
    v_cvt_pk_bf16_f32 v18, v18, v19
    v_and_b32 v17, 0xffff0000, v16
    v_lshlrev_b32 v16, 16, v16
    v_and_b32 v19, 0xffff0000, v18
    v_lshlrev_b32 v18, 16, v18
    v_lshlrev_b32 v84, 16, v240
    v_and_b32 v85, 0xffff0000, v240
    v_lshlrev_b32 v86, 16, v241
    v_and_b32 v87, 0xffff0000, v241
    v_pk_add_f32 v[16:17], v[16:17], v[84:85]
    v_pk_add_f32 v[18:19], v[18:19], v[86:87]
    v_cvt_pk_bf16_f32 v64, v16, v17
    v_cvt_pk_bf16_f32 v65, v18, v19
    v_lshlrev_b32 v16, 16, v64
    v_and_b32 v17, 0xffff0000, v64
    v_lshlrev_b32 v18, 16, v65
    v_and_b32 v19, 0xffff0000, v65
    v_pk_add_f32 v[84:85], v[16:17], v[18:19]
    v_pk_mul_f32 v[86:87], v[16:17], v[16:17]
    v_pk_fma_f32 v[86:87], v[18:19], v[18:19], v[86:87]
    v_add_f32 v72, v84, v85
    v_add_f32 v73, v86, v87
    v_cvt_pk_bf16_f32 v20, v20, v21
    v_cvt_pk_bf16_f32 v22, v22, v23
    v_and_b32 v21, 0xffff0000, v20
    v_lshlrev_b32 v20, 16, v20
    v_and_b32 v23, 0xffff0000, v22
    v_lshlrev_b32 v22, 16, v22
    v_lshlrev_b32 v84, 16, v242
    v_and_b32 v85, 0xffff0000, v242
    v_lshlrev_b32 v86, 16, v243
    v_and_b32 v87, 0xffff0000, v243
    v_pk_add_f32 v[20:21], v[20:21], v[84:85]
    v_pk_add_f32 v[22:23], v[22:23], v[86:87]
    v_cvt_pk_bf16_f32 v64, v20, v21
    v_cvt_pk_bf16_f32 v65, v22, v23
    v_lshlrev_b32 v20, 16, v64
    v_and_b32 v21, 0xffff0000, v64
    v_lshlrev_b32 v22, 16, v65
    v_and_b32 v23, 0xffff0000, v65
    v_pk_add_f32 v[84:85], v[20:21], v[22:23]
    v_pk_mul_f32 v[86:87], v[20:21], v[20:21]
    v_pk_fma_f32 v[86:87], v[22:23], v[22:23], v[86:87]
    v_add_f32 v74, v84, v85
    v_add_f32 v75, v86, v87
    v_cvt_pk_bf16_f32 v24, v24, v25
    v_cvt_pk_bf16_f32 v26, v26, v27
    v_and_b32 v25, 0xffff0000, v24
    v_lshlrev_b32 v24, 16, v24
    v_and_b32 v27, 0xffff0000, v26
    v_lshlrev_b32 v26, 16, v26
    v_lshlrev_b32 v84, 16, v244
    v_and_b32 v85, 0xffff0000, v244
    v_lshlrev_b32 v86, 16, v245
    v_and_b32 v87, 0xffff0000, v245
    v_pk_add_f32 v[24:25], v[24:25], v[84:85]
    v_pk_add_f32 v[26:27], v[26:27], v[86:87]
    v_cvt_pk_bf16_f32 v64, v24, v25
    v_cvt_pk_bf16_f32 v65, v26, v27
    v_lshlrev_b32 v24, 16, v64
    v_and_b32 v25, 0xffff0000, v64
    v_lshlrev_b32 v26, 16, v65
    v_and_b32 v27, 0xffff0000, v65
    v_pk_add_f32 v[84:85], v[24:25], v[26:27]
    v_pk_mul_f32 v[86:87], v[24:25], v[24:25]
    v_pk_fma_f32 v[86:87], v[26:27], v[26:27], v[86:87]
    v_add_f32 v76, v84, v85
    v_add_f32 v77, v86, v87
    v_cvt_pk_bf16_f32 v28, v28, v29
    v_cvt_pk_bf16_f32 v30, v30, v31
    v_and_b32 v29, 0xffff0000, v28
    v_lshlrev_b32 v28, 16, v28
    v_and_b32 v31, 0xffff0000, v30
    v_lshlrev_b32 v30, 16, v30
    v_lshlrev_b32 v84, 16, v246
    v_and_b32 v85, 0xffff0000, v246
    v_lshlrev_b32 v86, 16, v247
    v_and_b32 v87, 0xffff0000, v247
    v_pk_add_f32 v[28:29], v[28:29], v[84:85]
    v_pk_add_f32 v[30:31], v[30:31], v[86:87]
    v_cvt_pk_bf16_f32 v64, v28, v29
    v_cvt_pk_bf16_f32 v65, v30, v31
    v_lshlrev_b32 v28, 16, v64
    v_and_b32 v29, 0xffff0000, v64
    v_lshlrev_b32 v30, 16, v65
    v_and_b32 v31, 0xffff0000, v65
    v_pk_add_f32 v[84:85], v[28:29], v[30:31]
    v_pk_mul_f32 v[86:87], v[28:29], v[28:29]
    v_pk_fma_f32 v[86:87], v[30:31], v[30:31], v[86:87]
    v_add_f32 v78, v84, v85
    v_add_f32 v79, v86, v87
    v_lshlrev_b32 v15, 9, v3
    v_lshl_add_u32 v15, v2, 3, v15
    s_lshl_b32 s61, s3, 11
    s_add_u32 s61, s61, 74752
    v_add_u32 v15, s61, v15
    ds_write_b64 v15, v[72:73] offset:0
    ds_write_b64 v15, v[74:75] offset:128
    ds_write_b64 v15, v[76:77] offset:256
    ds_write_b64 v15, v[78:79] offset:384
    s_waitcnt lgkmcnt(0)
    s_barrier
    s_lshl_b32 s61, s4, 3
    s_lshl_b32 s64, s3, 1
    s_add_u32 s61, s61, s64
    s_lshl_b32 s61, s61, 15
    s_lshl_b32 s64, s5, 10
    s_add_u32 s61, s61, s64
    s_add_u32 s61, s61, 16781312
    s_add_u32 s62, s61, 32768
    v_lshlrev_b32 v15, 3, v1
    v_add_u32 v15, 74752, v15
    ds_read_b64 v[84:85], v15 offset:0
    ds_read_b64 v[86:87], v15 offset:512
    ds_read_b64 v[88:89], v15 offset:1024
    ds_read_b64 v[90:91], v15 offset:1536
    ds_read_b64 v[92:93], v15 offset:2048
    ds_read_b64 v[94:95], v15 offset:2560
    ds_read_b64 v[96:97], v15 offset:3072
    ds_read_b64 v[98:99], v15 offset:3584
    s_waitcnt lgkmcnt(0)
    ds_read_b64 v[100:101], v15 offset:4096
    ds_read_b64 v[102:103], v15 offset:4608
    ds_read_b64 v[104:105], v15 offset:5120
    ds_read_b64 v[106:107], v15 offset:5632
    ds_read_b64 v[108:109], v15 offset:6144
    ds_read_b64 v[110:111], v15 offset:6656
    ds_read_b64 v[112:113], v15 offset:7168
    ds_read_b64 v[114:115], v15 offset:7680
    v_pk_add_f32 v[84:85], v[84:85], v[92:93]
    v_pk_add_f32 v[86:87], v[86:87], v[94:95]
    v_pk_add_f32 v[88:89], v[88:89], v[96:97]
    v_pk_add_f32 v[90:91], v[90:91], v[98:99]
    v_pk_add_f32 v[84:85], v[84:85], v[88:89]
    v_pk_add_f32 v[86:87], v[86:87], v[90:91]
    v_pk_add_f32 v[84:85], v[84:85], v[86:87]
    s_waitcnt lgkmcnt(0)
    v_pk_add_f32 v[100:101], v[100:101], v[108:109]
    v_pk_add_f32 v[102:103], v[102:103], v[110:111]
    v_pk_add_f32 v[104:105], v[104:105], v[112:113]
    v_pk_add_f32 v[106:107], v[106:107], v[114:115]
    v_pk_add_f32 v[100:101], v[100:101], v[104:105]
    v_pk_add_f32 v[102:103], v[102:103], v[106:107]
    v_pk_add_f32 v[100:101], v[100:101], v[102:103]
    v_pk_add_f32 v[84:85], v[84:85], v[100:101]
    v_mov_b32 v86, s78
    v_mov_b32 v87, s79
    s_cmp_lg_u32 s74, 0
    s_cbranch_scc1 L_sp_38
    buffer_store_dwordx4 v[84:87], v4, s[40:43], s61 offen sc1
    buffer_store_dwordx4 v[84:87], v4, s[40:43], s62 offen sc1
    s_branch L_se_39
L_sp_38:
    buffer_store_dwordx4 v[84:87], v4, s[40:43], s61 offen
    buffer_store_dwordx4 v[84:87], v4, s[40:43], s62 offen
L_se_39:
    s_add_u32 s61, s68, 4096
    s_lshl_b32 s62, s3, 11
    s_add_u32 s61, s61, s62
    s_nop 1
    s_branch L_pst1b
L_pst1a:
    s_sleep 1
L_pst1b:
    buffer_load_dwordx4 v[84:87], v4, s[40:43], s61 offen offset:0 sc1
    buffer_load_dwordx4 v[88:91], v4, s[40:43], s61 offen offset:1024 sc1
    s_waitcnt vmcnt(0)
    v_cmp_ne_u64 vcc, s[78:79], v[86:87]
    v_cmp_ne_u64 s[72:73], s[78:79], v[90:91]
    s_nop 0
    s_or_b64 vcc, vcc, s[72:73]
    s_cbranch_vccnz L_pst1a
    v_pk_add_f32 v[84:85], v[84:85], v[88:89]
    s_lshl_b32 s62, s3, 9
    s_add_u32 s62, s62, 95488
    v_lshl_add_u32 v14, v1, 3, s62
    ds_write_b64 v14, v[84:85]
    v_lshlrev_b32 v14, 3, v2
    v_add_u32 v14, 95488, v14
    s_waitcnt lgkmcnt(0)
    s_barrier
    ds_read_b64 v[84:85], v14 offset:0
    ds_read_b64 v[86:87], v14 offset:512
    ds_read_b64 v[88:89], v14 offset:1024
    ds_read_b64 v[90:91], v14 offset:1536
    ds_read_b64 v[92:93], v14 offset:128
    ds_read_b64 v[94:95], v14 offset:640
    ds_read_b64 v[96:97], v14 offset:1152
    ds_read_b64 v[98:99], v14 offset:1664
    ds_read_b64 v[100:101], v14 offset:256
    ds_read_b64 v[102:103], v14 offset:768
    ds_read_b64 v[104:105], v14 offset:1280
    ds_read_b64 v[106:107], v14 offset:1792
    ds_read_b64 v[108:109], v14 offset:384
    ds_read_b64 v[110:111], v14 offset:896
    ds_read_b64 v[112:113], v14 offset:1408
    ds_read_b64 v[114:115], v14 offset:1920
    v_and_b32 v13, 1, v3
    v_lshl_add_u32 v13, v13, 4, v2
    v_lshlrev_b32 v13, 10, v13
    v_lshrrev_b32 v15, 1, v3
    v_lshl_add_u32 v13, v15, 4, v13
    s_lshl_b32 s62, s3, 5
    s_add_u32 s62, s62, s69
    s_add_u32 s63, s62, 32768
    s_waitcnt lgkmcnt(0)
    v_pk_add_f32 v[84:85], v[84:85], v[88:89]
    v_pk_add_f32 v[86:87], v[86:87], v[90:91]
    v_pk_add_f32 v[84:85], v[84:85], v[86:87]
    v_pk_add_f32 v[92:93], v[92:93], v[96:97]
    v_pk_add_f32 v[94:95], v[94:95], v[98:99]
    v_pk_add_f32 v[92:93], v[92:93], v[94:95]
    v_pk_add_f32 v[100:101], v[100:101], v[104:105]
    v_pk_add_f32 v[102:103], v[102:103], v[106:107]
    v_pk_add_f32 v[100:101], v[100:101], v[102:103]
    v_pk_add_f32 v[108:109], v[108:109], v[112:113]
    v_pk_add_f32 v[110:111], v[110:111], v[114:115]
    v_pk_add_f32 v[108:109], v[108:109], v[110:111]
    v_mul_f32 v88, 0x3b000000, v84
    v_mul_f32 v96, 0x3b000000, v92
    v_mul_f32 v104, 0x3b000000, v100
    v_mul_f32 v112, 0x3b000000, v108
    v_mul_f32 v89, 0x3b000000, v85
    v_mul_f32 v97, 0x3b000000, v93
    v_mul_f32 v105, 0x3b000000, v101
    v_mul_f32 v113, 0x3b000000, v109
    v_fma_f32 v89, -v88, v88, v89
    v_fma_f32 v97, -v96, v96, v97
    v_fma_f32 v105, -v104, v104, v105
    v_fma_f32 v113, -v112, v112, v113
    v_max_f32 v89, 0, v89
    v_max_f32 v97, 0, v97
    v_max_f32 v105, 0, v105
    v_max_f32 v113, 0, v113
    v_cvt_pk_bf16_f32 v88, v88, v89
    v_cvt_pk_bf16_f32 v96, v96, v97
    v_cvt_pk_bf16_f32 v104, v104, v105
    v_cvt_pk_bf16_f32 v112, v112, v113
    v_and_b32 v89, 0xffff0000, v88
    v_and_b32 v97, 0xffff0000, v96
    v_and_b32 v105, 0xffff0000, v104
    v_and_b32 v113, 0xffff0000, v112
    v_lshlrev_b32 v88, 16, v88
    v_lshlrev_b32 v96, 16, v96
    v_lshlrev_b32 v104, 16, v104
    v_lshlrev_b32 v112, 16, v112
    v_add_f32 v89, 0x3727c5ac, v89
    v_add_f32 v97, 0x3727c5ac, v97
    v_add_f32 v105, 0x3727c5ac, v105
    v_add_f32 v113, 0x3727c5ac, v113
    v_cvt_pk_bf16_f32 v89, v89, v89
    v_cvt_pk_bf16_f32 v97, v97, v97
    v_cvt_pk_bf16_f32 v105, v105, v105
    v_cvt_pk_bf16_f32 v113, v113, v113
    v_lshlrev_b32 v89, 16, v89
    v_lshlrev_b32 v97, 16, v97
    v_lshlrev_b32 v105, 16, v105
    v_lshlrev_b32 v113, 16, v113
    v_sqrt_f32 v89, v89
    v_sqrt_f32 v97, v97
    v_sqrt_f32 v105, v105
    v_sqrt_f32 v113, v113
    v_cvt_pk_bf16_f32 v89, v89, v89
    v_cvt_pk_bf16_f32 v97, v97, v97
    v_cvt_pk_bf16_f32 v105, v105, v105
    v_cvt_pk_bf16_f32 v113, v113, v113
    v_lshlrev_b32 v89, 16, v89
    v_lshlrev_b32 v97, 16, v97
    v_lshlrev_b32 v105, 16, v105
    v_lshlrev_b32 v113, 16, v113
    v_rcp_f32 v86, v89
    v_rcp_f32 v94, v97
    v_rcp_f32 v102, v105
    v_rcp_f32 v110, v113
    v_mul_f32 v87, -v88, v86
    v_mul_f32 v95, -v96, v94
    v_mul_f32 v103, -v104, v102
    v_mul_f32 v111, -v112, v110
    v_lshlrev_b32 v32, 16, v248
    v_and_b32 v33, 0xffff0000, v248
    v_lshlrev_b32 v34, 16, v249
    v_and_b32 v35, 0xffff0000, v249
    v_pk_fma_f32 v[36:37], v[16:17], v[86:87], v[86:87] op_sel:[0,0,1] op_sel_hi:[1,0,1]
    v_pk_fma_f32 v[36:37], v[36:37], v[32:33], v[16:17]
    v_pk_fma_f32 v[38:39], v[18:19], v[86:87], v[86:87] op_sel:[0,0,1] op_sel_hi:[1,0,1]
    v_pk_fma_f32 v[38:39], v[38:39], v[34:35], v[18:19]
    v_cvt_pk_bf16_f32 v240, v36, v37
    v_cvt_pk_bf16_f32 v241, v38, v39
    v_lshlrev_b32 v40, 16, v250
    v_and_b32 v41, 0xffff0000, v250
    v_lshlrev_b32 v42, 16, v251
    v_and_b32 v43, 0xffff0000, v251
    v_pk_fma_f32 v[44:45], v[20:21], v[94:95], v[94:95] op_sel:[0,0,1] op_sel_hi:[1,0,1]
    v_pk_fma_f32 v[44:45], v[44:45], v[40:41], v[20:21]
    v_pk_fma_f32 v[46:47], v[22:23], v[94:95], v[94:95] op_sel:[0,0,1] op_sel_hi:[1,0,1]
    v_pk_fma_f32 v[46:47], v[46:47], v[42:43], v[22:23]
    v_cvt_pk_bf16_f32 v242, v44, v45
    v_cvt_pk_bf16_f32 v243, v46, v47
    v_lshlrev_b32 v48, 16, v252
    v_and_b32 v49, 0xffff0000, v252
    v_lshlrev_b32 v50, 16, v253
    v_and_b32 v51, 0xffff0000, v253
    v_pk_fma_f32 v[52:53], v[24:25], v[102:103], v[102:103] op_sel:[0,0,1] op_sel_hi:[1,0,1]
    v_pk_fma_f32 v[52:53], v[52:53], v[48:49], v[24:25]
    v_pk_fma_f32 v[54:55], v[26:27], v[102:103], v[102:103] op_sel:[0,0,1] op_sel_hi:[1,0,1]
    v_pk_fma_f32 v[54:55], v[54:55], v[50:51], v[26:27]
    v_cvt_pk_bf16_f32 v244, v52, v53
    v_cvt_pk_bf16_f32 v245, v54, v55
    v_lshlrev_b32 v56, 16, v254
    v_and_b32 v57, 0xffff0000, v254
    v_lshlrev_b32 v58, 16, v255
    v_and_b32 v59, 0xffff0000, v255
    v_pk_fma_f32 v[60:61], v[28:29], v[110:111], v[110:111] op_sel:[0,0,1] op_sel_hi:[1,0,1]
    v_pk_fma_f32 v[60:61], v[60:61], v[56:57], v[28:29]
    v_pk_fma_f32 v[62:63], v[30:31], v[110:111], v[110:111] op_sel:[0,0,1] op_sel_hi:[1,0,1]
    v_pk_fma_f32 v[62:63], v[62:63], v[58:59], v[30:31]
    v_cvt_pk_bf16_f32 v246, v60, v61
    v_cvt_pk_bf16_f32 v247, v62, v63
    v_permlane16_swap_b32 v240, v242
    v_permlane16_swap_b32 v241, v243
    buffer_store_dwordx4 v[240:243], v13, s[32:35], s62 offen
    v_permlane16_swap_b32 v244, v246
    v_permlane16_swap_b32 v245, v247
    buffer_store_dwordx4 v[244:247], v13, s[32:35], s63 offen
L_end:
    s_endpgm
.section .rodata,"a"
.p2align 6
.amdhsa_kernel interleave_layers__sliding_local_dilated__ssm_conv_h3__prompt_kernel
  .amdhsa_next_free_vgpr 512
  .amdhsa_next_free_sgpr 102
  .amdhsa_accum_offset 256
  .amdhsa_group_segment_fixed_size 0
  .amdhsa_kernarg_size 96
  .amdhsa_user_sgpr_count 2
  .amdhsa_user_sgpr_kernarg_segment_ptr 1
  .amdhsa_system_sgpr_workgroup_id_x 1
.end_amdhsa_kernel
```
